```python
import torch

def _softmax(x, axis=-1):
    return torch.softmax(x, dim=axis)
def _gelu(x):
    return torch.nn.functional.gelu(x, approximate="tanh")
def _silu(x):
    return torch.nn.functional.silu(x)
def _sigmoid(x):
    return torch.sigmoid(x)
def _layernorm(x, axis=-1, eps=1e-5):
    m = x.mean(dim=axis, keepdim=True)
    v = x.var(dim=axis, keepdim=True, unbiased=False)
    return (x - m) / torch.sqrt(v + eps)
def _scatter_add(tgt, idx, src, axis=0):
    return tgt.clone().index_add_(axis, idx, src)
def _segment_sum(src, seg, n):
    out = torch.zeros((n,) + src.shape[1:], dtype=src.dtype)
    return out.index_add_(0, seg, src)
def _pad(x, pw):
    flat = tuple(v for pair in reversed(pw) for v in pair)
    return torch.nn.functional.pad(x, flat)

kernel_name = 'interleave_layers__sliding_local_dilated__moe_arch_mod__prompt'

def setup_inputs():

    _w = (lambda a: (lambda t: t.to(torch.bfloat16) if t.is_floating_point() else t)(torch.as_tensor(a)))
    def _A_setup():
        B, S, D = 1, 2048, 512
        return {
            "x": _w((lambda *s: torch.randn(*s, dtype=torch.bfloat16) * 0.05)(B, S, D)),
            "wqkv": _w((lambda *s: torch.randn(*s, dtype=torch.bfloat16) * 0.05)(D, 3 * D)),
            "wo": _w((lambda *s: torch.randn(*s, dtype=torch.bfloat16) * 0.05)(D, D)),
        }
    _A_in = _A_setup()

    def _B_setup():
        B, S, D, F, C = 1, 2048, 512, 1792, 2
        return {
            "x": _w((lambda *s: torch.randn(*s, dtype=torch.bfloat16) * 0.05)(B, S, D)),
            "w_r": _w((lambda *s: torch.randn(*s, dtype=torch.bfloat16) * 0.05)(D)),
            "w_gate": _w((lambda *s: torch.randn(*s, dtype=torch.bfloat16) * 0.05)(D, F)),
            "w_up": _w((lambda *s: torch.randn(*s, dtype=torch.bfloat16) * 0.05)(D, F)),
            "w_down": _w((lambda *s: torch.randn(*s, dtype=torch.bfloat16) * 0.05)(F, D)),
        }
    _B_in = _B_setup()

    return {
        "A_x": _A_in["x"],
        "A_wqkv": _A_in["wqkv"],
        "A_wo": _A_in["wo"],
        "B_x": _B_in["x"],
        "B_w_r": _B_in["w_r"],
        "B_w_gate": _B_in["w_gate"],
        "B_w_up": _B_in["w_up"],
        "B_w_down": _B_in["w_down"],
    }

def reference(A_x, A_wqkv, A_wo, B_x, B_w_r, B_w_gate, B_w_up, B_w_down):
    def _A_ref(x, wqkv, wo):
        B, S, D = x.shape
        H = 32; Dh = D // H
        W, dil = 8, 2
        qkv = (lambda x, *d: x.permute(*d))((x @ wqkv).reshape(B, S, 3, H, Dh), 2, 0, 3, 1, 4)
        q, k, v = qkv[0], qkv[1], qkv[2]
        scale = Dh ** -0.5
        pos = torch.arange(S)
        off = torch.arange(W) * dil
        idx = pos[:, None] - off[None, :]
        mask = idx >= 0
        idx_c = torch.where(mask, idx, 0).reshape(-1)
        kg = k[:, :, idx_c, :].reshape(B, H, S, W, Dh)
        vg = v[:, :, idx_c, :].reshape(B, H, S, W, Dh)
        logits = torch.einsum("bhsd,bhswd->bhsw", q, kg) * scale
        logits = torch.where(mask[None, None, :, :], logits, -1e9)
        attn = _softmax(logits, axis=-1)
        o = torch.einsum("bhsw,bhswd->bhsd", attn, vg)
        return (lambda x, *d: x.permute(*d))(o, 0, 2, 1, 3).reshape(B, S, D) @ wo

    def _B_ref(x, w_r, w_gate, w_up, w_down):
        B, S, D = x.shape
        C = 2
        r = x @ w_r
        idx = torch.argsort(-r, axis=-1)[:, :C]
        idx_e = (lambda x, n, axis: torch.repeat_interleave(x, n, dim=axis))(idx.reshape(B, C, 1), D, axis=2)
        x_sel = (lambda x, i, axis: torch.take_along_dim(x, i, dim=axis))(x, idx_e, axis=1)
        g = _silu(x_sel @ w_gate)
        u = x_sel @ w_up
        y = (g * u) @ w_down
        r_sel = _sigmoid((lambda x, i, axis: torch.take_along_dim(x, i, dim=axis))(r, idx, axis=1))
        y = y * r_sel.reshape(B, C, 1)
        b_off = (torch.arange(B) * S).reshape(B, 1)
        flat_idx = (idx + b_off).reshape(B * C)
        zero = (x * 0.0).reshape(B * S, D)
        upd = _scatter_add(zero, flat_idx, y.reshape(B * C, D), axis=0)
        return x + upd.reshape(B, S, D)

    x = A_x
    x = x + _A_ref(_layernorm(x, axis=-1), A_wqkv, A_wo)
    x = x + _B_ref(_layernorm(x, axis=-1), B_w_r, B_w_gate, B_w_up, B_w_down)
    x = x + _A_ref(_layernorm(x, axis=-1), A_wqkv, A_wo)
    x = x + _B_ref(_layernorm(x, axis=-1), B_w_r, B_w_gate, B_w_up, B_w_down)
    return x
```

```asm
; @launch grid=(256,1,1) block=(256,1,1) lds=163840
.amdgcn_target "amdgcn-amd-amdhsa--gfx950"
.text
.globl interleave_layers__sliding_local_dilated__moe_arch_mod__prompt_kernel
.p2align 8
.type interleave_layers__sliding_local_dilated__moe_arch_mod__prompt_kernel,@function
interleave_layers__sliding_local_dilated__moe_arch_mod__prompt_kernel:
L_entry:
    s_load_dwordx16 s[8:23], s[0:1], 0
    s_load_dwordx4 s[24:27], s[0:1], 64
    s_load_dwordx2 s[28:29], s[0:1], 80
    s_mov_b32 s92, 0
    s_cmp_ge_u32 s2, 256
    s_cbranch_scc1 L_end
    s_getpc_b64 s[96:97]
L_pc:
    s_lshr_b32 s5, s2, 3
    s_mul_i32 s5, s5, 12
    v_min_u32 v4, 11, v0
    v_add_u32 v4, s5, v4
    v_lshlrev_b32 v4, 7, v4
    v_min_u32 v4, L_code_end-L_pc-4, v4
    global_load_dword v254, v4, s[96:97]
    v_lshrrev_b32 v6, 6, v0
    v_and_b32 v1, 63, v0
    v_readfirstlane_b32 s3, v6
    v_bfe_u32 v2, v0, 4, 2
    v_and_b32 v3, 15, v0
    s_and_b32 s4, s2, 7
    s_lshr_b32 s5, s2, 3
    s_cmp_eq_u32 s4, 7
    s_cbranch_scc1 L_F
    s_lshr_b32 s6, s2, 6
    s_lshl2_add_u32 s6, s4, s6
    s_cmp_ge_u32 s6, 14
    s_cselect_b32 s30, 1, 0
    s_cselect_b32 s68, 14, 0
    s_sub_u32 s68, s6, s68
    s_mul_i32 s31, s68, 73
    s_lshl1_add_u32 s69, s31, s30
    s_lshl_b32 s69, s69, 10
    v_lshrrev_b32 v10, 4, v0
    v_xor_b32 v10, v10, v3
    v_lshlrev_b32 v10, 4, v10
    v_lshl_add_u32 v85, v2, 11, v10
    s_lshl_b32 s52, s3, 13
    s_add_u32 s62, s69, s52
    s_lshl_b32 s63, s3, 10
    s_add_u32 s52, s62, 131072
    s_sub_u32 s67, s62, 32768
    s_max_i32 s67, s67, 0
    v_add_u32 v72, s52, v85
    v_min_u32 v72, 2096368, v72
    s_mov_b32 s34, 2097152
    s_mov_b32 s35, 0x00020000
    s_mov_b32 s38, 1572864
    s_mov_b32 s39, 0x00020000
    s_waitcnt lgkmcnt(0)
    s_mov_b32 s32, s8
    s_and_b32 s33, s9, 0xffff
    s_add_u32 m0, s63, 0
    s_add_u32 s52, s62, 0
    buffer_load_dwordx4 v85, s[32:35], s52 offen offset:0 lds
    s_add_u32 m0, s63, 4096
    s_add_u32 s52, s62, 32768
    buffer_load_dwordx4 v85, s[32:35], s52 offen offset:0 lds
    s_add_u32 m0, s63, 8192
    s_add_u32 s52, s62, 65536
    buffer_load_dwordx4 v85, s[32:35], s52 offen offset:0 lds
    s_add_u32 m0, s63, 12288
    s_add_u32 s52, s62, 98304
    buffer_load_dwordx4 v85, s[32:35], s52 offen offset:0 lds
    s_add_u32 m0, s63, 16384
    s_nop 0
    buffer_load_dwordx4 v72, s[32:35], 0 offen offset:0 lds
    s_add_u32 m0, s63, 81920
    s_nop 0
    buffer_load_dwordx4 v85, s[32:35], s67 offen offset:0 lds
    s_load_dword s94, s[28:29], 0
    v_lshrrev_b32 v8, 3, v1
    s_lshl_b32 s53, s3, 3
    v_add_u32 v9, s53, v8
    v_bfe_u32 v14, v9, 1, 1
    v_bfe_u32 v11, v9, 3, 1
    v_lshl_add_u32 v14, v11, 1, v14
    v_bfe_u32 v11, v1, 1, 2
    v_sub_u32 v11, v11, v14
    v_and_b32 v11, 3, v11
    v_and_b32 v13, 1, v1
    v_lshlrev_b32 v13, 4, v13
    v_lshl_add_u32 v13, v11, 5, v13
    s_and_b32 s7, s5, 7
    s_lshl_b32 s52, s7, 7
    v_add_u32 v13, s52, v13
    v_mul_u32_u24 v99, 3072, v9
    v_add_u32 v99, v99, v13
    s_mul_i32 s64, s3, 3072
    s_add_u32 s64, s64, 98304
    s_mov_b32 s100, 98304
    s_mov_b32 s36, s10
    s_and_b32 s37, s11, 0xffff
    s_add_u32 m0, s64, 0
    s_mul_i32 s77, s100, 0
    buffer_load_dwordx4 v99, s[36:39], s77 offen offset:0 lds
    buffer_load_dwordx4 v99, s[36:39], s77 offen offset:1024 lds
    buffer_load_dwordx4 v99, s[36:39], s77 offen offset:2048 lds
    s_add_u32 m0, s64, 12288
    s_mul_i32 s77, s100, 1
    buffer_load_dwordx4 v99, s[36:39], s77 offen offset:0 lds
    buffer_load_dwordx4 v99, s[36:39], s77 offen offset:1024 lds
    buffer_load_dwordx4 v99, s[36:39], s77 offen offset:2048 lds
    v_lshl_add_u32 v98, v9, 10, v13
    v_lshl_add_u32 v12, v2, 10, v10
    v_lshl_add_u32 v15, v3, 8, v10
    v_add_u32 v16, 40960, v15
    s_lshl_b32 s52, s3, 6
    v_xor_b32 v4, s52, v15
    v_xor_b32 v5, 64, v4
    v_xor_b32 v6, 128, v4
    v_xor_b32 v7, 192, v4
    v_add_u32 v8, 40960, v4
    v_add_u32 v9, 40960, v5
    v_add_u32 v10, 40960, v6
    v_add_u32 v11, 40960, v7
    v_bfe_u32 v170, v1, 2, 2
    v_lshrrev_b32 v171, 1, v170
    v_and_b32 v172, 1, v2
    v_lshl_add_u32 v171, v172, 1, v171
    v_add_u32 v171, s3, v171
    v_and_b32 v171, 3, v171
    v_lshlrev_b32 v170, 7, v170
    v_lshl_add_u32 v170, v171, 5, v170
    v_and_b32 v172, 3, v1
    v_lshl_add_u32 v170, v172, 3, v170
    v_mul_u32_u24 v19, 3072, v2
    v_add_u32 v19, v19, v170
    v_add_u32 v19, 98304, v19
    v_mul_u32_u24 v82, 1024, v2
    v_add_u32 v82, v82, v170
    s_mov_b32 s78, 0x3f803f80
    v_mov_b32 v20, s78
    v_mov_b32 v21, s78
    v_mov_b32 v22, s78
    v_mov_b32 v23, s78
    s_add_u32 m0, s64, 24576
    s_mul_i32 s77, s100, 2
    buffer_load_dwordx4 v99, s[36:39], s77 offen offset:0 lds
    buffer_load_dwordx4 v99, s[36:39], s77 offen offset:1024 lds
    buffer_load_dwordx4 v99, s[36:39], s77 offen offset:2048 lds
    s_add_u32 m0, s64, 36864
    s_mul_i32 s77, s100, 3
    buffer_load_dwordx4 v99, s[36:39], s77 offen offset:0 lds
    buffer_load_dwordx4 v99, s[36:39], s77 offen offset:1024 lds
    buffer_load_dwordx4 v99, s[36:39], s77 offen offset:2048 lds
    s_add_u32 m0, s64, 49152
    s_mul_i32 s77, s100, 4
    buffer_load_dwordx4 v99, s[36:39], s77 offen offset:0 lds
    buffer_load_dwordx4 v99, s[36:39], s77 offen offset:1024 lds
    buffer_load_dwordx4 v99, s[36:39], s77 offen offset:2048 lds
    s_waitcnt lgkmcnt(0)
    s_waitcnt vmcnt(12)
    s_barrier
    ds_read_b128 v[160:163], v4 offset:0
    ds_read_b64_tr_b16 a[0:1], v19 offset:0
    ds_read_b64_tr_b16 a[2:3], v19 offset:512
    ds_read_b64_tr_b16 a[4:5], v19 offset:1024
    ds_read_b64_tr_b16 a[6:7], v19 offset:1536
    ds_read_b64_tr_b16 a[8:9], v19 offset:2048
    ds_read_b64_tr_b16 a[10:11], v19 offset:2560
    ds_read_b128 v[164:167], v4 offset:4096
    ds_read_b128 v[168:171], v4 offset:8192
    ds_read_b128 v[172:175], v4 offset:12288
    ds_read_b128 v[176:179], v4 offset:16384
    ds_read_b128 v[180:183], v8 offset:40960
    s_waitcnt lgkmcnt(9)
    v_mfma_f32_16x16x32_bf16 v[100:103], a[0:3], v[160:163], 0
    s_waitcnt vmcnt(9)
    s_barrier
    s_waitcnt lgkmcnt(7)
    v_mfma_f32_16x16x32_bf16 v[104:107], a[4:7], v[160:163], 0
    ds_read_b128 v[208:211], v15 offset:0
    s_mov_b32 s44, s28
    s_waitcnt lgkmcnt(6)
    v_mfma_f32_16x16x32_bf16 v[108:111], v[160:163], a[8:11], 0
    ds_read_b128 v[212:215], v15 offset:4096
    s_and_b32 s45, s29, 0xffff
    s_waitcnt lgkmcnt(6)
    v_mfma_f32_16x16x32_bf16 v[112:115], a[0:3], v[164:167], 0
    s_add_u32 m0, s63, 20224
    s_add_u32 s52, s62, 0
    v_mfma_f32_16x16x32_bf16 v[116:119], a[4:7], v[164:167], 0
    ds_read_b128 v[184:187], v5 offset:0
    buffer_load_dwordx4 v85, s[32:35], s52 offen offset:256 lds
    v_mfma_f32_16x16x32_bf16 v[120:123], v[164:167], a[8:11], 0
    ds_read_b64_tr_b16 a[12:13], v19 offset:12288
    s_mov_b32 s46, 268435456
    s_waitcnt lgkmcnt(7)
    v_mfma_f32_16x16x32_bf16 v[124:127], a[0:3], v[168:171], 0
    s_mov_b32 s47, 0x00020000
    s_add_u32 m0, s63, 24320
    v_mfma_f32_16x16x32_bf16 v[128:131], a[4:7], v[168:171], 0
    ds_read_b64_tr_b16 a[14:15], v19 offset:12800
    s_add_u32 s52, s62, 32768
    v_mfma_f32_16x16x32_bf16 v[132:135], v[168:171], a[8:11], 0
    ds_read_b64_tr_b16 a[16:17], v19 offset:13312
    buffer_load_dwordx4 v85, s[32:35], s52 offen offset:256 lds
    s_waitcnt lgkmcnt(7)
    v_mfma_f32_16x16x32_bf16 v[136:139], a[0:3], v[172:175], 0
    s_mul_i32 s90, s94, 0x9e3779b1
    s_add_u32 s90, s90, 0x7f4a7c15
    v_mfma_f32_16x16x32_bf16 v[140:143], a[4:7], v[172:175], 0
    ds_read_b64_tr_b16 a[18:19], v19 offset:13824
    s_getreg_b32 s81, hwreg(HW_REG_XCC_ID)
    v_mfma_f32_16x16x32_bf16 v[144:147], v[172:175], a[8:11], 0
    ds_read_b64_tr_b16 a[20:21], v19 offset:14336
    s_add_u32 m0, s63, 28416
    v_mfma_f32_16x16x32_bf16 v[148:151], a[0:3], v[176:179], 0
    s_add_u32 s52, s62, 65536
    buffer_load_dwordx4 v85, s[32:35], s52 offen offset:256 lds
    v_mfma_f32_16x16x32_bf16 v[152:155], a[4:7], v[176:179], 0
    ds_read_b64_tr_b16 a[22:23], v19 offset:14848
    s_and_b32 s81, s81, 15
    v_mfma_f32_16x16x32_bf16 v[156:159], v[176:179], a[8:11], 0
    ds_read_b128 v[188:191], v5 offset:4096
    v_mov_b32 v70, s81
    s_waitcnt lgkmcnt(6)
    v_mfma_f32_16x16x32_bf16 v[88:91], a[4:7], v[180:183], 0
    s_add_u32 m0, s63, 32512
    s_add_u32 s52, s62, 98304
    v_mfma_f32_16x16x32_bf16 v[92:95], v[180:183], a[8:11], 0
    ds_read_b128 v[192:195], v5 offset:8192
    buffer_load_dwordx4 v85, s[32:35], s52 offen offset:256 lds
    v_mfma_f32_16x16x32_bf16 v[36:39], a[0:3], v[20:23], 0
    ds_read_b128 v[196:199], v5 offset:12288
    v_mov_b32 v71, s90
    v_mfma_f32_16x16x32_bf16 v[40:43], a[4:7], v[20:23], 0
    v_mov_b32 v83, 0
    s_lshl_b32 s54, s6, 10
    v_mfma_f32_16x16x32_bf16 v[44:47], v[20:23], a[8:11], 0
    ds_read_b128 v[200:203], v5 offset:16384
    s_add_u32 m0, s63, 36608
    v_mfma_f32_16x16x32_bf16 v[216:219], v[208:211], v[208:211], 0
    ds_read_b128 v[204:207], v9 offset:40960
    v_mfma_f32_16x16x32_bf16 v[220:223], v[20:23], v[208:211], 0
    buffer_load_dwordx4 v72, s[32:35], 0 offen offset:256 lds
    v_mfma_f32_16x16x32_bf16 v[224:227], v[212:215], v[212:215], 0
    s_add_u32 s66, s54, 1179648
    s_lshl_b32 s55, s7, 7
    v_mfma_f32_16x16x32_bf16 v[228:231], v[20:23], v[212:215], 0
    s_add_u32 m0, s63, 85760
    s_nop 0
    buffer_load_dwordx4 v85, s[32:35], s67 offen offset:256 lds
    s_add_u32 s54, s66, s55
    s_waitcnt lgkmcnt(4)
    v_mfma_f32_16x16x32_bf16 v[100:103], a[12:15], v[184:187], v[100:103]
    s_waitcnt vmcnt(12)
    s_barrier
    v_mfma_f32_16x16x32_bf16 v[104:107], a[16:19], v[184:187], v[104:107]
    ds_read_b128 v[208:211], v15 offset:8192
    s_cmp_eq_u32 s3, 0
    s_cselect_b64 exec, 1, 0
    buffer_store_dwordx2 v[70:71], v83, s[44:47], s54 offen sc1
    s_mov_b64 exec, -1
    v_mfma_f32_16x16x32_bf16 v[108:111], v[184:187], a[20:23], v[108:111]
    ds_read_b128 v[212:215], v15 offset:12288
    v_lshlrev_b32 v57, 3, v1
    v_mfma_f32_16x16x32_bf16 v[112:115], a[12:15], v[188:191], v[112:115]
    s_add_u32 m0, s64, 0
    s_mul_i32 s77, s100, 5
    v_mfma_f32_16x16x32_bf16 v[116:119], a[16:19], v[188:191], v[116:119]
    ds_read_b128 v[160:163], v6 offset:0
    buffer_load_dwordx4 v99, s[36:39], s77 offen offset:0 lds
    v_mfma_f32_16x16x32_bf16 v[120:123], v[188:191], a[20:23], v[120:123]
    ds_read_b64_tr_b16 a[24:25], v19 offset:24576
    s_mov_b32 s73, 1146880
    s_waitcnt lgkmcnt(4)
    v_mfma_f32_16x16x32_bf16 v[124:127], a[12:15], v[192:195], v[124:127]
    s_cmp_eq_u32 s7, 3
    s_cselect_b64 s[98:99], -1, 0
    v_mfma_f32_16x16x32_bf16 v[128:131], a[16:19], v[192:195], v[128:131]
    ds_read_b64_tr_b16 a[26:27], v19 offset:25088
    buffer_load_dwordx4 v99, s[36:39], s77 offen offset:1024 lds
    v_mfma_f32_16x16x32_bf16 v[132:135], v[192:195], a[20:23], v[132:135]
    ds_read_b64_tr_b16 a[28:29], v19 offset:25600
    s_add_u32 s20, s28, 851968
    s_addc_u32 s21, s29, 0
    v_mfma_f32_16x16x32_bf16 v[136:139], a[12:15], v[196:199], v[136:139]
    s_and_b32 s21, s21, 0xffff
    buffer_load_dwordx4 v99, s[36:39], s77 offen offset:2048 lds
    v_mfma_f32_16x16x32_bf16 v[140:143], a[16:19], v[196:199], v[140:143]
    ds_read_b64_tr_b16 a[30:31], v19 offset:26112
    v_mfma_f32_16x16x32_bf16 v[144:147], v[196:199], a[20:23], v[144:147]
    ds_read_b64_tr_b16 a[32:33], v19 offset:26624
    s_add_u32 s22, s28, 1048576
    s_addc_u32 s23, s29, 0
    v_mfma_f32_16x16x32_bf16 v[148:151], a[12:15], v[200:203], v[148:151]
    s_and_b32 s23, s23, 0xffff
    s_mov_b32 s40, s12
    v_mfma_f32_16x16x32_bf16 v[152:155], a[16:19], v[200:203], v[152:155]
    ds_read_b64_tr_b16 a[34:35], v19 offset:27136
    s_add_u32 m0, s63, 40448
    v_mfma_f32_16x16x32_bf16 v[156:159], v[200:203], a[20:23], v[156:159]
    ds_read_b128 v[164:167], v6 offset:4096
    s_add_u32 s52, s62, 0
    v_mfma_f32_16x16x32_bf16 v[88:91], a[16:19], v[204:207], v[88:91]
    buffer_load_dwordx4 v85, s[32:35], s52 offen offset:512 lds
    v_mfma_f32_16x16x32_bf16 v[92:95], v[204:207], a[20:23], v[92:95]
    ds_read_b128 v[168:171], v6 offset:8192
    s_and_b32 s41, s13, 0xffff
    v_mfma_f32_16x16x32_bf16 v[36:39], a[12:15], v[20:23], v[36:39]
    ds_read_b128 v[172:175], v6 offset:12288
    s_mov_b32 s42, 524288
    v_mfma_f32_16x16x32_bf16 v[40:43], a[16:19], v[20:23], v[40:43]
    s_add_u32 m0, s63, 44544
    s_add_u32 s52, s62, 32768
    v_mfma_f32_16x16x32_bf16 v[44:47], v[20:23], a[20:23], v[44:47]
    ds_read_b128 v[176:179], v6 offset:16384
    s_waitcnt lgkmcnt(7)
    v_mfma_f32_16x16x32_bf16 v[232:235], v[208:211], v[208:211], 0
    ds_read_b128 v[180:183], v10 offset:40960
    buffer_load_dwordx4 v85, s[32:35], s52 offen offset:512 lds
    v_mfma_f32_16x16x32_bf16 v[236:239], v[20:23], v[208:211], 0
    s_mov_b32 s43, 0x00020000
    s_mov_b32 s101, 32768
    v_mfma_f32_16x16x32_bf16 v[240:243], v[212:215], v[212:215], 0
    s_add_u32 m0, s63, 48640
    s_add_u32 s52, s62, 65536
    v_mfma_f32_16x16x32_bf16 v[244:247], v[20:23], v[212:215], 0
    buffer_load_dwordx4 v85, s[32:35], s52 offen offset:512 lds
    v_lshlrev_b32 v65, 4, v1
    v_mfma_f32_16x16x32_bf16 v[100:103], a[24:27], v[160:163], v[100:103]
    s_waitcnt vmcnt(7)
    s_barrier
    s_waitcnt lgkmcnt(4)
    v_mfma_f32_16x16x32_bf16 v[104:107], a[28:31], v[160:163], v[104:107]
    ds_read_b128 v[208:211], v15 offset:16384
    s_mov_b32 s48, s24
    v_mfma_f32_16x16x32_bf16 v[108:111], v[160:163], a[32:35], v[108:111]
    ds_read_b128 v[212:215], v16 offset:40960
    s_and_b32 s49, s25, 0xffff
    v_mfma_f32_16x16x32_bf16 v[112:115], a[24:27], v[164:167], v[112:115]
    s_add_u32 m0, s64, 12288
    s_mul_i32 s77, s100, 6
    v_mfma_f32_16x16x32_bf16 v[116:119], a[28:31], v[164:167], v[116:119]
    ds_read_b128 v[184:187], v7 offset:0
    v_mfma_f32_16x16x32_bf16 v[120:123], v[164:167], a[32:35], v[120:123]
    ds_read_b64_tr_b16 a[36:37], v19 offset:36864
    s_waitcnt lgkmcnt(5)
    v_mfma_f32_16x16x32_bf16 v[124:127], a[24:27], v[168:171], v[124:127]
    buffer_load_dwordx4 v99, s[36:39], s77 offen offset:0 lds
    v_mfma_f32_16x16x32_bf16 v[128:131], a[28:31], v[168:171], v[128:131]
    ds_read_b64_tr_b16 a[38:39], v19 offset:37376
    s_mov_b32 s50, 2097152
    v_mfma_f32_16x16x32_bf16 v[132:135], v[168:171], a[32:35], v[132:135]
    ds_read_b64_tr_b16 a[40:41], v19 offset:37888
    s_mov_b32 s51, 0x00020000
    v_mfma_f32_16x16x32_bf16 v[136:139], a[24:27], v[172:175], v[136:139]
    buffer_load_dwordx4 v99, s[36:39], s77 offen offset:1024 lds
    v_mfma_f32_16x16x32_bf16 v[140:143], a[28:31], v[172:175], v[140:143]
    ds_read_b64_tr_b16 a[42:43], v19 offset:38400
    s_mul_i32 s72, s6, 267776
    v_mfma_f32_16x16x32_bf16 v[144:147], v[172:175], a[32:35], v[144:147]
    ds_read_b64_tr_b16 a[44:45], v19 offset:38912
    s_add_u32 s72, s72, 2097152
    v_mfma_f32_16x16x32_bf16 v[148:151], a[24:27], v[176:179], v[148:151]
    buffer_load_dwordx4 v99, s[36:39], s77 offen offset:2048 lds
    v_mfma_f32_16x16x32_bf16 v[152:155], a[28:31], v[176:179], v[152:155]
    ds_read_b64_tr_b16 a[46:47], v19 offset:39424
    s_mov_b32 s8, 0x7ffffff1
    v_mfma_f32_16x16x32_bf16 v[156:159], v[176:179], a[32:35], v[156:159]
    ds_read_b128 v[188:191], v7 offset:4096
    s_mov_b32 s9, 0x7ffffff1
    s_waitcnt lgkmcnt(8)
    v_mfma_f32_16x16x32_bf16 v[88:91], a[28:31], v[180:183], v[88:91]
    s_mov_b32 s12, 135168
    s_add_u32 m0, s63, 52736
    v_mfma_f32_16x16x32_bf16 v[92:95], v[180:183], a[32:35], v[92:95]
    ds_read_b128 v[192:195], v7 offset:8192
    s_add_u32 s52, s62, 98304
    v_mfma_f32_16x16x32_bf16 v[36:39], a[24:27], v[20:23], v[36:39]
    ds_read_b128 v[196:199], v7 offset:12288
    buffer_load_dwordx4 v85, s[32:35], s52 offen offset:512 lds
    v_mfma_f32_16x16x32_bf16 v[40:43], a[28:31], v[20:23], v[40:43]
    s_movk_i32 s13, 80
    s_mov_b32 s18, 0xfffff800
    v_mfma_f32_16x16x32_bf16 v[44:47], v[20:23], a[32:35], v[44:47]
    ds_read_b128 v[200:203], v7 offset:16384
    s_add_u32 m0, s63, 56832
    v_mfma_f32_16x16x32_bf16 v[74:77], v[208:211], v[208:211], 0
    ds_read_b128 v[204:207], v11 offset:40960
    v_mfma_f32_16x16x32_bf16 v[78:81], v[20:23], v[208:211], 0
    buffer_load_dwordx4 v72, s[32:35], 0 offen offset:512 lds
    v_mfma_f32_16x16x32_bf16 v[48:51], v[212:215], v[212:215], 0
    s_lshl_b32 s54, s7, 7
    s_lshl_b32 s55, s3, 5
    v_mfma_f32_16x16x32_bf16 v[52:55], v[20:23], v[212:215], 0
    s_add_u32 m0, s63, 89600
    s_nop 0
    buffer_load_dwordx4 v85, s[32:35], s67 offen offset:512 lds
    s_add_u32 s54, s54, s55
    s_waitcnt lgkmcnt(4)
    v_mfma_f32_16x16x32_bf16 v[100:103], a[36:39], v[184:187], v[100:103]
    s_barrier
    v_mfma_f32_16x16x32_bf16 v[104:107], a[40:43], v[184:187], v[104:107]
    ds_read_b128 v[208:211], v15 offset:20480
    v_lshlrev_b32 v14, 3, v2
    v_mfma_f32_16x16x32_bf16 v[108:111], v[184:187], a[44:47], v[108:111]
    ds_read_b128 v[212:215], v15 offset:24576
    s_mov_b64 exec, s[98:99]
    buffer_load_dwordx2 v[58:59], v57, s[44:47], s73 offen sc1
    s_mov_b64 exec, -1
    v_mfma_f32_16x16x32_bf16 v[112:115], a[36:39], v[188:191], v[112:115]
    v_add_u32 v14, s54, v14
    v_lshl_add_u32 v13, v3, 10, v14
    v_mfma_f32_16x16x32_bf16 v[116:119], a[40:43], v[188:191], v[116:119]
    ds_read_b128 v[160:163], v4 offset:20480
    s_add_u32 m0, s64, 24576
    v_mfma_f32_16x16x32_bf16 v[120:123], v[188:191], a[44:47], v[120:123]
    ds_read_b64_tr_b16 a[48:49], v19 offset:49152
    s_mul_i32 s77, s100, 7
    s_waitcnt lgkmcnt(4)
    v_mfma_f32_16x16x32_bf16 v[124:127], a[36:39], v[192:195], v[124:127]
    buffer_load_dwordx4 v99, s[36:39], s77 offen offset:0 lds
    v_mfma_f32_16x16x32_bf16 v[128:131], a[40:43], v[192:195], v[128:131]
    ds_read_b64_tr_b16 a[50:51], v19 offset:49664
    v_lshl_add_u32 v18, v3, 11, v14
    v_mfma_f32_16x16x32_bf16 v[132:135], v[192:195], a[44:47], v[132:135]
    ds_read_b64_tr_b16 a[52:53], v19 offset:50176
    s_lshr_b32 s54, s69, 10
    v_mfma_f32_16x16x32_bf16 v[136:139], a[36:39], v[196:199], v[136:139]
    buffer_load_dwordx4 v99, s[36:39], s77 offen offset:1024 lds
    v_mfma_f32_16x16x32_bf16 v[140:143], a[40:43], v[196:199], v[140:143]
    ds_read_b64_tr_b16 a[54:55], v19 offset:50688
    v_lshlrev_b32 v17, 1, v3
    v_mfma_f32_16x16x32_bf16 v[144:147], v[196:199], a[44:47], v[144:147]
    ds_read_b64_tr_b16 a[56:57], v19 offset:51200
    v_add_u32 v17, s54, v17
    v_mfma_f32_16x16x32_bf16 v[148:151], a[36:39], v[200:203], v[148:151]
    buffer_load_dwordx4 v99, s[36:39], s77 offen offset:2048 lds
    v_mfma_f32_16x16x32_bf16 v[152:155], a[40:43], v[200:203], v[152:155]
    ds_read_b64_tr_b16 a[58:59], v19 offset:51712
    s_lshl_b32 s54, s7, 4
    v_mfma_f32_16x16x32_bf16 v[156:159], v[200:203], a[44:47], v[156:159]
    ds_read_b128 v[164:167], v4 offset:24576
    s_lshl_b32 s55, s3, 2
    v_mfma_f32_16x16x32_bf16 v[88:91], a[40:43], v[204:207], v[88:91]
    s_add_u32 m0, s63, 60672
    s_add_u32 s52, s62, 0
    v_mfma_f32_16x16x32_bf16 v[92:95], v[204:207], a[44:47], v[92:95]
    ds_read_b128 v[168:171], v4 offset:28672
    buffer_load_dwordx4 v85, s[32:35], s52 offen offset:768 lds
    v_mfma_f32_16x16x32_bf16 v[36:39], a[36:39], v[20:23], v[36:39]
    ds_read_b128 v[172:175], v4 offset:32768
    s_add_u32 s65, s54, s55
    v_mfma_f32_16x16x32_bf16 v[40:43], a[40:43], v[20:23], v[40:43]
    v_and_b32 v64, 7, v1
    s_add_u32 m0, s63, 64768
    v_mfma_f32_16x16x32_bf16 v[44:47], v[20:23], a[44:47], v[44:47]
    ds_read_b128 v[176:179], v4 offset:36864
    s_add_u32 s52, s62, 32768
    s_waitcnt lgkmcnt(6)
    v_mfma_f32_16x16x32_bf16 v[216:219], v[208:211], v[208:211], v[216:219]
    ds_read_b128 v[180:183], v8 offset:45056
    buffer_load_dwordx4 v85, s[32:35], s52 offen offset:768 lds
    v_mfma_f32_16x16x32_bf16 v[220:223], v[20:23], v[208:211], v[220:223]
    v_lshlrev_b32 v64, 7, v64
    v_mov_b32 v83, 4284592614
    v_mfma_f32_16x16x32_bf16 v[224:227], v[212:215], v[212:215], v[224:227]
    s_add_u32 m0, s63, 68864
    s_add_u32 s52, s62, 65536
    v_mfma_f32_16x16x32_bf16 v[228:231], v[20:23], v[212:215], v[228:231]
    buffer_load_dwordx4 v85, s[32:35], s52 offen offset:768 lds
    v_mov_b32 v248, 0
    v_mfma_f32_16x16x32_bf16 v[100:103], a[48:51], v[160:163], v[100:103]
    s_waitcnt vmcnt(16)
    s_barrier
    v_mfma_f32_16x16x32_bf16 v[104:107], a[52:55], v[160:163], v[104:107]
    ds_read_b128 v[208:211], v15 offset:28672
    v_mov_b32 v249, 0
    s_waitcnt lgkmcnt(4)
    v_mfma_f32_16x16x32_bf16 v[108:111], v[160:163], a[56:59], v[108:111]
    ds_read_b128 v[212:215], v15 offset:32768
    s_mov_b64 exec, s[98:99]
    buffer_load_dwordx2 v[58:59], v57, s[44:47], s73 offen sc1
    s_mov_b64 exec, -1
    v_mfma_f32_16x16x32_bf16 v[112:115], a[48:51], v[164:167], v[112:115]
    v_mov_b32 v250, 0
    v_mov_b32 v251, 0
    v_mfma_f32_16x16x32_bf16 v[116:119], a[52:55], v[164:167], v[116:119]
    ds_read_b128 v[184:187], v5 offset:20480
    s_add_u32 m0, s64, 36864
    v_mfma_f32_16x16x32_bf16 v[120:123], v[164:167], a[56:59], v[120:123]
    ds_read_b64_tr_b16 a[60:61], v19 offset:0
    s_mul_i32 s77, s100, 8
    v_mfma_f32_16x16x32_bf16 v[124:127], a[48:51], v[168:171], v[124:127]
    buffer_load_dwordx4 v99, s[36:39], s77 offen offset:0 lds
    v_mfma_f32_16x16x32_bf16 v[128:131], a[52:55], v[168:171], v[128:131]
    ds_read_b64_tr_b16 a[62:63], v19 offset:512
    s_cmp_lg_u32 s68, 0
    s_cselect_b64 s[70:71], -1, 0
    v_mfma_f32_16x16x32_bf16 v[132:135], v[168:171], a[56:59], v[132:135]
    ds_read_b64_tr_b16 a[64:65], v19 offset:1024
    v_lshl_add_u32 v70, v2, 2, 0
    s_waitcnt lgkmcnt(6)
    v_mfma_f32_16x16x32_bf16 v[136:139], a[48:51], v[172:175], v[136:139]
    buffer_load_dwordx4 v99, s[36:39], s77 offen offset:1024 lds
    v_mfma_f32_16x16x32_bf16 v[140:143], a[52:55], v[172:175], v[140:143]
    ds_read_b64_tr_b16 a[66:67], v19 offset:1536
    v_sub_u32 v70, v3, v70
    v_mfma_f32_16x16x32_bf16 v[144:147], v[172:175], a[56:59], v[144:147]
    ds_read_b64_tr_b16 a[68:69], v19 offset:2048
    v_cmp_gt_u32 s[84:85], 8, v70
    v_mfma_f32_16x16x32_bf16 v[148:151], a[48:51], v[176:179], v[148:151]
    buffer_load_dwordx4 v99, s[36:39], s77 offen offset:2048 lds
    v_mfma_f32_16x16x32_bf16 v[152:155], a[52:55], v[176:179], v[152:155]
    ds_read_b64_tr_b16 a[70:71], v19 offset:2560
    v_or_b32 v71, 0xffff, v250
    v_mfma_f32_16x16x32_bf16 v[156:159], v[176:179], a[56:59], v[156:159]
    ds_read_b128 v[188:191], v5 offset:24576
    v_cndmask_b32 v24, v83, 0, s[84:85]
    v_mfma_f32_16x16x32_bf16 v[88:91], a[52:55], v[180:183], v[88:91]
    s_add_u32 m0, s63, 72960
    s_add_u32 s52, s62, 98304
    v_mfma_f32_16x16x32_bf16 v[92:95], v[180:183], a[56:59], v[92:95]
    ds_read_b128 v[192:195], v5 offset:28672
    v_mfma_f32_16x16x32_bf16 v[36:39], a[48:51], v[20:23], v[36:39]
    ds_read_b128 v[196:199], v5 offset:32768
    buffer_load_dwordx4 v85, s[32:35], s52 offen offset:768 lds
    v_mfma_f32_16x16x32_bf16 v[40:43], a[52:55], v[20:23], v[40:43]
    v_cndmask_b32 v250, v250, v71, s[84:85]
    v_cmp_ge_i32 s[84:85], -9, v70
    v_mfma_f32_16x16x32_bf16 v[44:47], v[20:23], a[56:59], v[44:47]
    ds_read_b128 v[200:203], v5 offset:36864
    s_add_u32 m0, s63, 77056
    s_waitcnt lgkmcnt(7)
    v_mfma_f32_16x16x32_bf16 v[232:235], v[208:211], v[208:211], v[232:235]
    ds_read_b128 v[204:207], v9 offset:45056
    v_mfma_f32_16x16x32_bf16 v[236:239], v[20:23], v[208:211], v[236:239]
    buffer_load_dwordx4 v72, s[32:35], 0 offen offset:768 lds
    v_mfma_f32_16x16x32_bf16 v[240:243], v[212:215], v[212:215], v[240:243]
    v_or_b32 v71, 0xffff, v248
    v_cndmask_b32 v28, v83, 0, s[84:85]
    v_mfma_f32_16x16x32_bf16 v[244:247], v[20:23], v[212:215], v[244:247]
    s_add_u32 m0, s63, 93440
    s_nop 0
    buffer_load_dwordx4 v85, s[32:35], s67 offen offset:768 lds
    v_cndmask_b32 v248, v248, v71, s[84:85]
    v_mfma_f32_16x16x32_bf16 v[100:103], a[60:63], v[184:187], v[100:103]
    s_waitcnt vmcnt(14)
    s_barrier
    s_waitcnt vmcnt(13)
    v_cmp_eq_u32 vcc, s90, v58
    v_cmp_eq_u32 s[96:97], s90, v59
    s_nop 0
    s_and_b64 vcc, vcc, s[96:97]
    s_and_b64 vcc, vcc, s[98:99]
    s_cmp_eq_u64 vcc, -1
    s_cbranch_scc0 Lsw_1
    s_mov_b32 s36, s20
    s_mov_b32 s37, s21
    s_mov_b32 s38, 196608
    s_mov_b32 s40, s22
    s_mov_b32 s41, s23
    s_mov_b32 s42, 65536
    s_mov_b32 s100, 12288
    s_movk_i32 s101, 4096
    s_mul_i32 s53, s3, 3072
    v_add_u32 v99, s53, v65
    v_add_u32 v98, s63, v65
    s_mov_b64 s[98:99], 0
    Lsw_1:
    s_waitcnt lgkmcnt(0)
    v_mfma_f32_16x16x32_bf16 v[104:107], a[64:67], v[184:187], v[104:107]
    ds_read_b128 v[208:211], v15 offset:36864
    v_cndmask_b32 v32, v83, v28, s[70:71]
    v_mfma_f32_16x16x32_bf16 v[108:111], v[184:187], a[68:71], v[108:111]
    ds_read_b128 v[212:215], v16 offset:45056
    v_lshl_add_u32 v70, v2, 2, 1
    v_mfma_f32_16x16x32_bf16 v[112:115], a[60:63], v[188:191], v[112:115]
    s_add_u32 m0, s64, 49152
    s_mul_i32 s77, s100, 9
    v_mfma_f32_16x16x32_bf16 v[116:119], a[64:67], v[188:191], v[116:119]
    ds_read_b128 v[160:163], v6 offset:20480
    buffer_load_dwordx4 v99, s[36:39], s77 offen offset:0 lds
    v_mfma_f32_16x16x32_bf16 v[120:123], v[188:191], a[68:71], v[120:123]
    ds_read_b64_tr_b16 a[72:73], v19 offset:12288
    v_sub_u32 v70, v3, v70
    v_mfma_f32_16x16x32_bf16 v[124:127], a[60:63], v[192:195], v[124:127]
    v_cmp_gt_u32 s[84:85], 8, v70
    buffer_load_dwordx4 v99, s[36:39], s77 offen offset:1024 lds
    v_mfma_f32_16x16x32_bf16 v[128:131], a[64:67], v[192:195], v[128:131]
    ds_read_b64_tr_b16 a[74:75], v19 offset:12800
    v_or_b32 v71, 0xffff0000, v250
    v_mfma_f32_16x16x32_bf16 v[132:135], v[192:195], a[68:71], v[132:135]
    ds_read_b64_tr_b16 a[76:77], v19 offset:13312
    v_cndmask_b32 v25, v83, 0, s[84:85]
    v_mfma_f32_16x16x32_bf16 v[136:139], a[60:63], v[196:199], v[136:139]
    buffer_load_dwordx4 v99, s[36:39], s77 offen offset:2048 lds
    v_mfma_f32_16x16x32_bf16 v[140:143], a[64:67], v[196:199], v[140:143]
    ds_read_b64_tr_b16 a[78:79], v19 offset:13824
    v_cndmask_b32 v250, v250, v71, s[84:85]
    v_mfma_f32_16x16x32_bf16 v[144:147], v[196:199], a[68:71], v[144:147]
    ds_read_b64_tr_b16 a[80:81], v19 offset:14336
    v_cmp_ge_i32 s[84:85], -9, v70
    v_mfma_f32_16x16x32_bf16 v[148:151], a[60:63], v[200:203], v[148:151]
    v_or_b32 v71, 0xffff0000, v248
    s_add_u32 m0, s63, 0
    v_mfma_f32_16x16x32_bf16 v[152:155], a[64:67], v[200:203], v[152:155]
    ds_read_b64_tr_b16 a[82:83], v19 offset:14848
    s_mul_i32 s52, s101, 0
    v_mfma_f32_16x16x32_bf16 v[156:159], v[200:203], a[68:71], v[156:159]
    ds_read_b128 v[164:167], v6 offset:24576
    v_mfma_f32_16x16x32_bf16 v[88:91], a[64:67], v[204:207], v[88:91]
    buffer_load_dwordx4 v98, s[40:43], s52 offen lds
    v_mfma_f32_16x16x32_bf16 v[92:95], v[204:207], a[68:71], v[92:95]
    ds_read_b128 v[168:171], v6 offset:28672
    v_cndmask_b32 v29, v83, 0, s[84:85]
    v_mfma_f32_16x16x32_bf16 v[36:39], a[60:63], v[20:23], v[36:39]
    ds_read_b128 v[172:175], v6 offset:32768
    v_cndmask_b32 v248, v248, v71, s[84:85]
    v_mfma_f32_16x16x32_bf16 v[40:43], a[64:67], v[20:23], v[40:43]
    s_add_u32 m0, s63, 4096
    s_mul_i32 s52, s101, 1
    v_mfma_f32_16x16x32_bf16 v[44:47], v[20:23], a[68:71], v[44:47]
    ds_read_b128 v[176:179], v6 offset:36864
    s_waitcnt lgkmcnt(7)
    v_mfma_f32_16x16x32_bf16 v[74:77], v[208:211], v[208:211], v[74:77]
    ds_read_b128 v[180:183], v10 offset:45056
    buffer_load_dwordx4 v98, s[40:43], s52 offen lds
    v_mfma_f32_16x16x32_bf16 v[78:81], v[20:23], v[208:211], v[78:81]
    v_cndmask_b32 v33, v83, v29, s[70:71]
    v_lshl_add_u32 v70, v2, 2, 2
    v_mfma_f32_16x16x32_bf16 v[48:51], v[212:215], v[212:215], v[48:51]
    s_add_u32 m0, s63, 8192
    s_mul_i32 s52, s101, 2
    v_mfma_f32_16x16x32_bf16 v[52:55], v[20:23], v[212:215], v[52:55]
    buffer_load_dwordx4 v98, s[40:43], s52 offen lds
    v_sub_u32 v70, v3, v70
    v_mfma_f32_16x16x32_bf16 v[100:103], a[72:75], v[160:163], v[100:103]
    s_waitcnt vmcnt(16)
    s_barrier
    s_waitcnt vmcnt(12)
    v_cmp_eq_u32 vcc, s90, v58
    v_cmp_eq_u32 s[96:97], s90, v59
    s_nop 0
    s_and_b64 vcc, vcc, s[96:97]
    s_and_b64 vcc, vcc, s[98:99]
    s_cmp_eq_u64 vcc, -1
    s_cbranch_scc0 Lsw_2
    s_mov_b32 s36, s20
    s_mov_b32 s37, s21
    s_mov_b32 s38, 196608
    s_mov_b32 s40, s22
    s_mov_b32 s41, s23
    s_mov_b32 s42, 65536
    s_mov_b32 s100, 12288
    s_movk_i32 s101, 4096
    s_mul_i32 s53, s3, 3072
    v_add_u32 v99, s53, v65
    v_add_u32 v98, s63, v65
    s_mov_b64 s[98:99], 0
    Lsw_2:
    s_waitcnt lgkmcnt(0)
    v_mfma_f32_16x16x32_bf16 v[104:107], a[76:79], v[160:163], v[104:107]
    ds_read_b128 v[208:211], v16 offset:0
    v_cmp_gt_u32 s[84:85], 8, v70
    v_mfma_f32_16x16x32_bf16 v[108:111], v[160:163], a[80:83], v[108:111]
    ds_read_b128 v[212:215], v16 offset:4096
    v_or_b32 v71, 0xffff, v251
    v_mfma_f32_16x16x32_bf16 v[112:115], a[72:75], v[164:167], v[112:115]
    s_add_u32 m0, s64, 0
    s_mul_i32 s77, s100, 10
    v_mfma_f32_16x16x32_bf16 v[116:119], a[76:79], v[164:167], v[116:119]
    ds_read_b128 v[184:187], v7 offset:20480
    buffer_load_dwordx4 v99, s[36:39], s77 offen offset:0 lds
    v_mfma_f32_16x16x32_bf16 v[120:123], v[164:167], a[80:83], v[120:123]
    ds_read_b64_tr_b16 a[84:85], v19 offset:24576
    v_cndmask_b32 v26, v83, 0, s[84:85]
    v_mfma_f32_16x16x32_bf16 v[124:127], a[72:75], v[168:171], v[124:127]
    v_cndmask_b32 v251, v251, v71, s[84:85]
    buffer_load_dwordx4 v99, s[36:39], s77 offen offset:1024 lds
    v_mfma_f32_16x16x32_bf16 v[128:131], a[76:79], v[168:171], v[128:131]
    ds_read_b64_tr_b16 a[86:87], v19 offset:25088
    v_cmp_ge_i32 s[84:85], -9, v70
    v_mfma_f32_16x16x32_bf16 v[132:135], v[168:171], a[80:83], v[132:135]
    ds_read_b64_tr_b16 a[88:89], v19 offset:25600
    v_or_b32 v71, 0xffff, v249
    v_mfma_f32_16x16x32_bf16 v[136:139], a[72:75], v[172:175], v[136:139]
    buffer_load_dwordx4 v99, s[36:39], s77 offen offset:2048 lds
    v_mfma_f32_16x16x32_bf16 v[140:143], a[76:79], v[172:175], v[140:143]
    ds_read_b64_tr_b16 a[90:91], v19 offset:26112
    v_cndmask_b32 v30, v83, 0, s[84:85]
    v_mfma_f32_16x16x32_bf16 v[144:147], v[172:175], a[80:83], v[144:147]
    ds_read_b64_tr_b16 a[92:93], v19 offset:26624
    v_cndmask_b32 v249, v249, v71, s[84:85]
    v_mfma_f32_16x16x32_bf16 v[148:151], a[72:75], v[176:179], v[148:151]
    v_cndmask_b32 v34, v83, v30, s[70:71]
    s_add_u32 m0, s63, 12288
    v_mfma_f32_16x16x32_bf16 v[152:155], a[76:79], v[176:179], v[152:155]
    ds_read_b64_tr_b16 a[94:95], v19 offset:27136
    s_mul_i32 s52, s101, 3
    v_mfma_f32_16x16x32_bf16 v[156:159], v[176:179], a[80:83], v[156:159]
    ds_read_b128 v[188:191], v7 offset:24576
    v_mfma_f32_16x16x32_bf16 v[88:91], a[76:79], v[180:183], v[88:91]
    buffer_load_dwordx4 v98, s[40:43], s52 offen lds
    v_mfma_f32_16x16x32_bf16 v[92:95], v[180:183], a[80:83], v[92:95]
    ds_read_b128 v[192:195], v7 offset:28672
    v_lshl_add_u32 v70, v2, 2, 3
    v_mfma_f32_16x16x32_bf16 v[36:39], a[72:75], v[20:23], v[36:39]
    ds_read_b128 v[196:199], v7 offset:32768
    v_sub_u32 v70, v3, v70
    v_mfma_f32_16x16x32_bf16 v[40:43], a[76:79], v[20:23], v[40:43]
    s_add_u32 m0, s63, 16384
    s_mul_i32 s52, s101, 4
    v_mfma_f32_16x16x32_bf16 v[44:47], v[20:23], a[80:83], v[44:47]
    ds_read_b128 v[200:203], v7 offset:36864
    s_waitcnt lgkmcnt(7)
    v_mfma_f32_16x16x32_bf16 v[216:219], v[208:211], v[208:211], v[216:219]
    ds_read_b128 v[204:207], v11 offset:45056
    buffer_load_dwordx4 v98, s[40:43], s52 offen lds
    v_mfma_f32_16x16x32_bf16 v[220:223], v[20:23], v[208:211], v[220:223]
    v_cmp_gt_u32 s[84:85], 8, v70
    v_or_b32 v71, 0xffff0000, v251
    v_mfma_f32_16x16x32_bf16 v[224:227], v[212:215], v[212:215], v[224:227]
    s_add_u32 m0, s63, 81920
    s_mul_i32 s52, s101, 5
    v_mfma_f32_16x16x32_bf16 v[228:231], v[20:23], v[212:215], v[228:231]
    buffer_load_dwordx4 v98, s[40:43], s52 offen lds
    v_cndmask_b32 v27, v83, 0, s[84:85]
    v_mfma_f32_16x16x32_bf16 v[100:103], a[84:87], v[184:187], v[100:103]
    s_waitcnt vmcnt(15)
    s_barrier
    s_waitcnt lgkmcnt(4)
    v_mfma_f32_16x16x32_bf16 v[104:107], a[88:91], v[184:187], v[104:107]
    ds_read_b128 v[208:211], v16 offset:8192
    v_cndmask_b32 v251, v251, v71, s[84:85]
    v_mfma_f32_16x16x32_bf16 v[108:111], v[184:187], a[92:95], v[108:111]
    ds_read_b128 v[212:215], v16 offset:12288
    v_cmp_ge_i32 s[84:85], -9, v70
    v_mfma_f32_16x16x32_bf16 v[112:115], a[84:87], v[188:191], v[112:115]
    v_or_b32 v71, 0xffff0000, v249
    s_add_u32 m0, s64, 12288
    v_mfma_f32_16x16x32_bf16 v[116:119], a[88:91], v[188:191], v[116:119]
    ds_read_b128 v[160:163], v8 offset:0
    s_mul_i32 s77, s100, 11
    v_mfma_f32_16x16x32_bf16 v[120:123], v[188:191], a[92:95], v[120:123]
    ds_read_b64_tr_b16 a[96:97], v19 offset:36864
    s_waitcnt lgkmcnt(5)
    v_mfma_f32_16x16x32_bf16 v[124:127], a[84:87], v[192:195], v[124:127]
    buffer_load_dwordx4 v99, s[36:39], s77 offen offset:0 lds
    v_mfma_f32_16x16x32_bf16 v[128:131], a[88:91], v[192:195], v[128:131]
    ds_read_b64_tr_b16 a[98:99], v19 offset:37376
    v_cndmask_b32 v31, v83, 0, s[84:85]
    v_mfma_f32_16x16x32_bf16 v[132:135], v[192:195], a[92:95], v[132:135]
    ds_read_b64_tr_b16 a[100:101], v19 offset:37888
    v_cndmask_b32 v249, v249, v71, s[84:85]
    v_mfma_f32_16x16x32_bf16 v[136:139], a[84:87], v[196:199], v[136:139]
    v_cndmask_b32 v35, v83, v31, s[70:71]
    s_mov_b32 s79, 1052289595
    v_mfma_f32_16x16x32_bf16 v[140:143], a[88:91], v[196:199], v[140:143]
    ds_read_b64_tr_b16 a[102:103], v19 offset:38400
    v_mfma_f32_16x16x32_bf16 v[144:147], v[196:199], a[92:95], v[144:147]
    ds_read_b64_tr_b16 a[104:105], v19 offset:38912
    v_mfma_f32_16x16x32_bf16 v[148:151], a[84:87], v[200:203], v[148:151]
    buffer_load_dwordx4 v99, s[36:39], s77 offen offset:1024 lds
    v_mfma_f32_16x16x32_bf16 v[152:155], a[88:91], v[200:203], v[152:155]
    ds_read_b64_tr_b16 a[106:107], v19 offset:39424
    v_lshlrev_b32 v252, 2, v3
    v_mfma_f32_16x16x32_bf16 v[156:159], v[200:203], a[92:95], v[156:159]
    ds_read_b128 v[164:167], v8 offset:4096
    v_add_u32 v252, 159744, v252
    s_waitcnt lgkmcnt(8)
    v_mfma_f32_16x16x32_bf16 v[88:91], a[88:91], v[204:207], v[88:91]
    v_lshlrev_b32 v253, 4, v2
    v_add_u32 v253, 159744, v253
    v_mfma_f32_16x16x32_bf16 v[92:95], v[204:207], a[92:95], v[92:95]
    ds_read_b128 v[168:171], v8 offset:8192
    v_and_b32 v70, 3, v3
    v_mfma_f32_16x16x32_bf16 v[36:39], a[84:87], v[20:23], v[36:39]
    ds_read_b128 v[172:175], v8 offset:12288
    v_mfma_f32_16x16x32_bf16 v[40:43], a[88:91], v[20:23], v[40:43]
    buffer_load_dwordx4 v99, s[36:39], s77 offen offset:2048 lds
    v_mfma_f32_16x16x32_bf16 v[44:47], v[20:23], a[92:95], v[44:47]
    ds_read_b128 v[176:179], v8 offset:16384
    v_cmp_eq_u32 s[56:57], 1, v70
    v_mfma_f32_16x16x32_bf16 v[232:235], v[208:211], v[208:211], v[232:235]
    ds_read_b128 v[180:183], v8 offset:49152
    v_cmp_eq_u32 s[58:59], 2, v70
    v_mfma_f32_16x16x32_bf16 v[236:239], v[20:23], v[208:211], v[236:239]
    v_mfma_f32_16x16x32_bf16 v[240:243], v[212:215], v[212:215], v[240:243]
    v_mfma_f32_16x16x32_bf16 v[244:247], v[20:23], v[212:215], v[244:247]
    s_waitcnt lgkmcnt(6)
    v_mfma_f32_16x16x32_bf16 v[100:103], a[96:99], v[160:163], v[100:103]
    s_waitcnt vmcnt(12)
    s_barrier
    v_mfma_f32_16x16x32_bf16 v[104:107], a[100:103], v[160:163], v[104:107]
    ds_read_b128 v[208:211], v16 offset:16384
    v_cmp_eq_u32 s[60:61], 3, v70
    s_waitcnt lgkmcnt(6)
    v_mfma_f32_16x16x32_bf16 v[108:111], v[160:163], a[104:107], v[108:111]
    ds_read_b128 v[212:215], v16 offset:49152
    v_lshrrev_b32 v70, 2, v3
    s_waitcnt lgkmcnt(6)
    v_mfma_f32_16x16x32_bf16 v[112:115], a[96:99], v[164:167], v[112:115]
    s_add_u32 m0, s64, 24576
    s_mul_i32 s77, s100, 12
    v_mfma_f32_16x16x32_bf16 v[116:119], a[100:103], v[164:167], v[116:119]
    ds_read_b128 v[184:187], v9 offset:0
    buffer_load_dwordx4 v99, s[36:39], s77 offen offset:0 lds
    v_mfma_f32_16x16x32_bf16 v[120:123], v[164:167], a[104:107], v[120:123]
    ds_read_b64_tr_b16 a[108:109], v19 offset:49152
    v_cmp_eq_u32 s[84:85], v70, v2
    s_waitcnt lgkmcnt(6)
    v_mfma_f32_16x16x32_bf16 v[124:127], a[96:99], v[168:171], v[124:127]
    s_lshl_b32 s54, s3, 3
    buffer_load_dwordx4 v99, s[36:39], s77 offen offset:1024 lds
    v_mfma_f32_16x16x32_bf16 v[128:131], a[100:103], v[168:171], v[128:131]
    ds_read_b64_tr_b16 a[110:111], v19 offset:49664
    s_add_u32 s54, s54, 110592
    v_mfma_f32_16x16x32_bf16 v[132:135], v[168:171], a[104:107], v[132:135]
    ds_read_b64_tr_b16 a[112:113], v19 offset:50176
    v_lshlrev_b32 v70, 5, v3
    v_mfma_f32_16x16x32_bf16 v[136:139], a[96:99], v[172:175], v[136:139]
    buffer_load_dwordx4 v99, s[36:39], s77 offen offset:2048 lds
    v_mfma_f32_16x16x32_bf16 v[140:143], a[100:103], v[172:175], v[140:143]
    ds_read_b64_tr_b16 a[114:115], v19 offset:50688
    v_add_u32 v70, s54, v70
    v_mfma_f32_16x16x32_bf16 v[144:147], v[172:175], a[104:107], v[144:147]
    ds_read_b64_tr_b16 a[116:117], v19 offset:51200
    v_lshlrev_b32 v71, 3, v1
    s_waitcnt lgkmcnt(6)
    v_mfma_f32_16x16x32_bf16 v[148:151], a[96:99], v[176:179], v[148:151]
    v_add_u32 v71, 113664, v71
    s_add_u32 m0, s63, 20480
    v_mfma_f32_16x16x32_bf16 v[152:155], a[100:103], v[176:179], v[152:155]
    ds_read_b64_tr_b16 a[118:119], v19 offset:51712
    s_mul_i32 s52, s101, 6
    v_mfma_f32_16x16x32_bf16 v[156:159], v[176:179], a[104:107], v[156:159]
    ds_read_b128 v[188:191], v9 offset:4096
    v_mfma_f32_16x16x32_bf16 v[88:91], a[100:103], v[180:183], v[88:91]
    buffer_load_dwordx4 v98, s[40:43], s52 offen lds
    v_mfma_f32_16x16x32_bf16 v[92:95], v[180:183], a[104:107], v[92:95]
    ds_read_b128 v[192:195], v9 offset:8192
    v_cndmask_b32 v60, v71, v70, s[84:85]
    v_mfma_f32_16x16x32_bf16 v[36:39], a[96:99], v[20:23], v[36:39]
    ds_read_b128 v[196:199], v9 offset:12288
    v_min_u32 v62, 95, v0
    v_mfma_f32_16x16x32_bf16 v[40:43], a[100:103], v[20:23], v[40:43]
    s_add_u32 m0, s63, 24576
    s_mul_i32 s52, s101, 7
    v_mfma_f32_16x16x32_bf16 v[44:47], v[20:23], a[104:107], v[44:47]
    ds_read_b128 v[200:203], v9 offset:16384
    v_mfma_f32_16x16x32_bf16 v[74:77], v[208:211], v[208:211], v[74:77]
    ds_read_b128 v[204:207], v9 offset:49152
    buffer_load_dwordx4 v98, s[40:43], s52 offen lds
    v_mfma_f32_16x16x32_bf16 v[78:81], v[20:23], v[208:211], v[78:81]
    v_lshlrev_b32 v63, 5, v62
    v_add_u32 v63, 110592, v63
    v_mfma_f32_16x16x32_bf16 v[48:51], v[212:215], v[212:215], v[48:51]
    s_add_u32 m0, s63, 28672
    s_mul_i32 s52, s101, 8
    v_mfma_f32_16x16x32_bf16 v[52:55], v[20:23], v[212:215], v[52:55]
    buffer_load_dwordx4 v98, s[40:43], s52 offen lds
    v_lshlrev_b32 v62, 2, v62
    s_waitcnt lgkmcnt(5)
    v_mfma_f32_16x16x32_bf16 v[100:103], a[108:111], v[184:187], v[100:103]
    s_waitcnt vmcnt(12)
    s_barrier
    v_mfma_f32_16x16x32_bf16 v[104:107], a[112:115], v[184:187], v[104:107]
    ds_read_b128 v[208:211], v16 offset:20480
    v_add_u32 v62, 159744, v62
    v_mfma_f32_16x16x32_bf16 v[108:111], v[184:187], a[116:119], v[108:111]
    ds_read_b128 v[212:215], v16 offset:24576
    s_add_u32 m0, s64, 36864
    s_waitcnt lgkmcnt(5)
    v_mfma_f32_16x16x32_bf16 v[112:115], a[108:111], v[188:191], v[112:115]
    s_mul_i32 s77, s100, 13
    v_mfma_f32_16x16x32_bf16 v[116:119], a[112:115], v[188:191], v[116:119]
    ds_read_b128 v[160:163], v10 offset:0
    v_mfma_f32_16x16x32_bf16 v[120:123], v[188:191], a[116:119], v[120:123]
    ds_read_b64_tr_b16 a[120:121], v19 offset:0
    v_mfma_f32_16x16x32_bf16 v[124:127], a[108:111], v[192:195], v[124:127]
    buffer_load_dwordx4 v99, s[36:39], s77 offen offset:0 lds
    v_mfma_f32_16x16x32_bf16 v[128:131], a[112:115], v[192:195], v[128:131]
    ds_read_b64_tr_b16 a[122:123], v19 offset:512
    v_mul_u32_u24 v70, 80, v3
    v_mfma_f32_16x16x32_bf16 v[132:135], v[192:195], a[116:119], v[132:135]
    ds_read_b64_tr_b16 a[124:125], v19 offset:1024
    s_lshl_b32 s54, s3, 4
    s_waitcnt lgkmcnt(6)
    v_mfma_f32_16x16x32_bf16 v[136:139], a[108:111], v[196:199], v[136:139]
    buffer_load_dwordx4 v99, s[36:39], s77 offen offset:1024 lds
    v_mfma_f32_16x16x32_bf16 v[140:143], a[112:115], v[196:199], v[140:143]
    ds_read_b64_tr_b16 a[126:127], v19 offset:1536
    s_add_u32 s54, s54, 98304
    v_mfma_f32_16x16x32_bf16 v[144:147], v[196:199], a[116:119], v[144:147]
    ds_read_b64_tr_b16 a[128:129], v19 offset:2048
    v_mfma_f32_16x16x32_bf16 v[148:151], a[108:111], v[200:203], v[148:151]
    buffer_load_dwordx4 v99, s[36:39], s77 offen offset:2048 lds
    v_mfma_f32_16x16x32_bf16 v[152:155], a[112:115], v[200:203], v[152:155]
    ds_read_b64_tr_b16 a[130:131], v19 offset:2560
    v_add_u32 v70, s54, v70
    v_mfma_f32_16x16x32_bf16 v[156:159], v[200:203], a[116:119], v[156:159]
    ds_read_b128 v[164:167], v10 offset:4096
    v_lshlrev_b32 v71, 4, v1
    v_mfma_f32_16x16x32_bf16 v[88:91], a[112:115], v[204:207], v[88:91]
    s_add_u32 m0, s63, 32768
    s_mul_i32 s52, s101, 9
    v_mfma_f32_16x16x32_bf16 v[92:95], v[204:207], a[116:119], v[92:95]
    ds_read_b128 v[168:171], v10 offset:8192
    v_mfma_f32_16x16x32_bf16 v[36:39], a[108:111], v[20:23], v[36:39]
    ds_read_b128 v[172:175], v10 offset:12288
    buffer_load_dwordx4 v98, s[40:43], s52 offen lds
    v_mfma_f32_16x16x32_bf16 v[40:43], a[112:115], v[20:23], v[40:43]
    v_add_u32 v71, 106496, v71
    s_add_u32 m0, s63, 36864
    v_mfma_f32_16x16x32_bf16 v[44:47], v[20:23], a[116:119], v[44:47]
    ds_read_b128 v[176:179], v10 offset:16384
    s_mul_i32 s52, s101, 10
    s_waitcnt lgkmcnt(7)
    v_mfma_f32_16x16x32_bf16 v[216:219], v[208:211], v[208:211], v[216:219]
    ds_read_b128 v[180:183], v10 offset:49152
    v_mfma_f32_16x16x32_bf16 v[220:223], v[20:23], v[208:211], v[220:223]
    buffer_load_dwordx4 v98, s[40:43], s52 offen lds
    v_mfma_f32_16x16x32_bf16 v[224:227], v[212:215], v[212:215], v[224:227]
    v_cmp_eq_u32 s[84:85], 0, v2
    s_nop 1
    v_cndmask_b32 v84, v71, v70, s[84:85]
    v_mfma_f32_16x16x32_bf16 v[228:231], v[20:23], v[212:215], v[228:231]
    s_add_u32 m0, s63, 86016
    s_mul_i32 s52, s101, 11
    buffer_load_dwordx4 v98, s[40:43], s52 offen lds
    v_mfma_f32_16x16x32_bf16 v[100:103], a[120:123], v[160:163], v[100:103]
    s_waitcnt vmcnt(12)
    s_barrier
    s_waitcnt lgkmcnt(4)
    v_mfma_f32_16x16x32_bf16 v[104:107], a[124:127], v[160:163], v[104:107]
    ds_read_b128 v[208:211], v16 offset:28672
    s_add_u32 m0, s64, 49152
    v_mfma_f32_16x16x32_bf16 v[108:111], v[160:163], a[128:131], v[108:111]
    ds_read_b128 v[212:215], v16 offset:32768
    s_mul_i32 s77, s100, 14
    v_mfma_f32_16x16x32_bf16 v[112:115], a[120:123], v[164:167], v[112:115]
    buffer_load_dwordx4 v99, s[36:39], s77 offen offset:0 lds
    v_mfma_f32_16x16x32_bf16 v[116:119], a[124:127], v[164:167], v[116:119]
    ds_read_b128 v[184:187], v11 offset:0
    v_mfma_f32_16x16x32_bf16 v[120:123], v[164:167], a[128:131], v[120:123]
    ds_read_b64_tr_b16 a[132:133], v19 offset:12288
    s_waitcnt lgkmcnt(6)
    v_mfma_f32_16x16x32_bf16 v[124:127], a[120:123], v[168:171], v[124:127]
    buffer_load_dwordx4 v99, s[36:39], s77 offen offset:1024 lds
    v_mfma_f32_16x16x32_bf16 v[128:131], a[124:127], v[168:171], v[128:131]
    ds_read_b64_tr_b16 a[134:135], v19 offset:12800
    v_mfma_f32_16x16x32_bf16 v[132:135], v[168:171], a[128:131], v[132:135]
    ds_read_b64_tr_b16 a[136:137], v19 offset:13312
    v_mfma_f32_16x16x32_bf16 v[136:139], a[120:123], v[172:175], v[136:139]
    buffer_load_dwordx4 v99, s[36:39], s77 offen offset:2048 lds
    v_mfma_f32_16x16x32_bf16 v[140:143], a[124:127], v[172:175], v[140:143]
    ds_read_b64_tr_b16 a[138:139], v19 offset:13824
    v_mfma_f32_16x16x32_bf16 v[144:147], v[172:175], a[128:131], v[144:147]
    ds_read_b64_tr_b16 a[140:141], v19 offset:14336
    s_waitcnt lgkmcnt(8)
    v_mfma_f32_16x16x32_bf16 v[148:151], a[120:123], v[176:179], v[148:151]
    global_load_dwordx2 v[66:67], v14, s[16:17]
    v_mfma_f32_16x16x32_bf16 v[152:155], a[124:127], v[176:179], v[152:155]
    ds_read_b64_tr_b16 a[142:143], v19 offset:14848
    v_mfma_f32_16x16x32_bf16 v[156:159], v[176:179], a[128:131], v[156:159]
    ds_read_b128 v[188:191], v11 offset:4096
    v_mfma_f32_16x16x32_bf16 v[88:91], a[124:127], v[180:183], v[88:91]
    global_load_dwordx4 v[68:71], v65, s[16:17]
    v_mfma_f32_16x16x32_bf16 v[92:95], v[180:183], a[128:131], v[92:95]
    ds_read_b128 v[192:195], v11 offset:8192
    v_mfma_f32_16x16x32_bf16 v[36:39], a[120:123], v[20:23], v[36:39]
    ds_read_b128 v[196:199], v11 offset:12288
    v_mfma_f32_16x16x32_bf16 v[40:43], a[124:127], v[20:23], v[40:43]
    v_mfma_f32_16x16x32_bf16 v[44:47], v[20:23], a[128:131], v[44:47]
    ds_read_b128 v[200:203], v11 offset:16384
    s_waitcnt lgkmcnt(9)
    v_mfma_f32_16x16x32_bf16 v[232:235], v[208:211], v[208:211], v[232:235]
    ds_read_b128 v[204:207], v11 offset:49152
    v_mfma_f32_16x16x32_bf16 v[236:239], v[20:23], v[208:211], v[236:239]
    v_mfma_f32_16x16x32_bf16 v[240:243], v[212:215], v[212:215], v[240:243]
    v_mfma_f32_16x16x32_bf16 v[244:247], v[20:23], v[212:215], v[244:247]
    s_waitcnt lgkmcnt(9)
    v_mfma_f32_16x16x32_bf16 v[100:103], a[132:135], v[184:187], v[100:103]
    s_waitcnt vmcnt(14)
    s_barrier
    s_waitcnt lgkmcnt(7)
    v_mfma_f32_16x16x32_bf16 v[104:107], a[136:139], v[184:187], v[104:107]
    ds_read_b128 v[208:211], v16 offset:36864
    s_add_u32 m0, s64, 0
    s_waitcnt lgkmcnt(6)
    v_mfma_f32_16x16x32_bf16 v[108:111], v[184:187], a[140:143], v[108:111]
    ds_read_b128 v[212:215], v16 offset:53248
    s_mul_i32 s77, s100, 15
    s_waitcnt lgkmcnt(6)
    v_mfma_f32_16x16x32_bf16 v[112:115], a[132:135], v[188:191], v[112:115]
    buffer_load_dwordx4 v99, s[36:39], s77 offen offset:0 lds
    v_mfma_f32_16x16x32_bf16 v[116:119], a[136:139], v[188:191], v[116:119]
    ds_read_b128 v[160:163], v8 offset:20480
    v_mfma_f32_16x16x32_bf16 v[120:123], v[188:191], a[140:143], v[120:123]
    ds_read_b64_tr_b16 a[144:145], v19 offset:24576
    s_waitcnt lgkmcnt(7)
    v_mfma_f32_16x16x32_bf16 v[124:127], a[132:135], v[192:195], v[124:127]
    buffer_load_dwordx4 v99, s[36:39], s77 offen offset:1024 lds
    v_mfma_f32_16x16x32_bf16 v[128:131], a[136:139], v[192:195], v[128:131]
    ds_read_b64_tr_b16 a[146:147], v19 offset:25088
    v_mfma_f32_16x16x32_bf16 v[132:135], v[192:195], a[140:143], v[132:135]
    ds_read_b64_tr_b16 a[148:149], v19 offset:25600
    s_waitcnt lgkmcnt(8)
    v_mfma_f32_16x16x32_bf16 v[136:139], a[132:135], v[196:199], v[136:139]
    buffer_load_dwordx4 v99, s[36:39], s77 offen offset:2048 lds
    v_mfma_f32_16x16x32_bf16 v[140:143], a[136:139], v[196:199], v[140:143]
    ds_read_b64_tr_b16 a[150:151], v19 offset:26112
    v_mfma_f32_16x16x32_bf16 v[144:147], v[196:199], a[140:143], v[144:147]
    ds_read_b64_tr_b16 a[152:153], v19 offset:26624
    s_waitcnt lgkmcnt(8)
    v_mfma_f32_16x16x32_bf16 v[148:151], a[132:135], v[200:203], v[148:151]
    buffer_load_dwordx2 v[58:59], v64, s[44:47], s66 offen sc1
    v_mfma_f32_16x16x32_bf16 v[152:155], a[136:139], v[200:203], v[152:155]
    ds_read_b64_tr_b16 a[154:155], v19 offset:27136
    v_mfma_f32_16x16x32_bf16 v[156:159], v[200:203], a[140:143], v[156:159]
    ds_read_b128 v[164:167], v8 offset:24576
    v_mfma_f32_16x16x32_bf16 v[88:91], a[136:139], v[204:207], v[88:91]
    v_mfma_f32_16x16x32_bf16 v[92:95], v[204:207], a[140:143], v[92:95]
    ds_read_b128 v[168:171], v8 offset:28672
    v_mfma_f32_16x16x32_bf16 v[36:39], a[132:135], v[20:23], v[36:39]
    ds_read_b128 v[172:175], v8 offset:32768
    v_mfma_f32_16x16x32_bf16 v[40:43], a[136:139], v[20:23], v[40:43]
    v_mfma_f32_16x16x32_bf16 v[44:47], v[20:23], a[140:143], v[44:47]
    ds_read_b128 v[176:179], v8 offset:36864
    s_waitcnt lgkmcnt(10)
    v_mfma_f32_16x16x32_bf16 v[74:77], v[208:211], v[208:211], v[74:77]
    ds_read_b128 v[180:183], v8 offset:53248
    v_mfma_f32_16x16x32_bf16 v[78:81], v[20:23], v[208:211], v[78:81]
    v_mfma_f32_16x16x32_bf16 v[48:51], v[212:215], v[212:215], v[48:51]
    v_mfma_f32_16x16x32_bf16 v[52:55], v[20:23], v[212:215], v[52:55]
    s_waitcnt lgkmcnt(9)
    v_mfma_f32_16x16x32_bf16 v[100:103], a[144:147], v[160:163], v[100:103]
    s_waitcnt vmcnt(12)
    s_barrier
    s_waitcnt lgkmcnt(7)
    v_mfma_f32_16x16x32_bf16 v[104:107], a[148:151], v[160:163], v[104:107]
    ds_read_b128 v[184:187], v9 offset:20480
    s_or_b64 s[96:97], s[58:59], s[60:61]
    s_waitcnt lgkmcnt(6)
    v_mfma_f32_16x16x32_bf16 v[108:111], v[160:163], a[152:155], v[108:111]
    ds_read_b64_tr_b16 a[156:157], v19 offset:36864
    v_cndmask_b32 v216, v216, v217, s[56:57]
    s_waitcnt lgkmcnt(6)
    v_mfma_f32_16x16x32_bf16 v[112:115], a[144:147], v[164:167], v[112:115]
    ds_read_b64_tr_b16 a[158:159], v19 offset:37376
    v_cndmask_b32 v218, v218, v219, s[60:61]
    v_mfma_f32_16x16x32_bf16 v[116:119], a[148:151], v[164:167], v[116:119]
    s_add_u32 m0, s63, 40960
    s_mul_i32 s52, s101, 12
    v_mfma_f32_16x16x32_bf16 v[120:123], v[164:167], a[152:155], v[120:123]
    ds_read_b64_tr_b16 a[160:161], v19 offset:37888
    buffer_load_dwordx4 v98, s[40:43], s52 offen lds
    s_waitcnt lgkmcnt(7)
    v_mfma_f32_16x16x32_bf16 v[124:127], a[144:147], v[168:171], v[124:127]
    ds_read_b64_tr_b16 a[162:163], v19 offset:38400
    v_cndmask_b32 v221, v216, v218, s[96:97]
    v_mfma_f32_16x16x32_bf16 v[128:131], a[148:151], v[168:171], v[128:131]
    ds_write_b64 v60, v[220:221] offset:0
    v_mfma_f32_16x16x32_bf16 v[132:135], v[168:171], a[152:155], v[132:135]
    ds_read_b64_tr_b16 a[164:165], v19 offset:38912
    v_cndmask_b32 v224, v224, v225, s[56:57]
    s_waitcnt lgkmcnt(7)
    v_mfma_f32_16x16x32_bf16 v[136:139], a[144:147], v[172:175], v[136:139]
    ds_read_b64_tr_b16 a[166:167], v19 offset:39424
    v_cndmask_b32 v226, v226, v227, s[60:61]
    v_mfma_f32_16x16x32_bf16 v[140:143], a[148:151], v[172:175], v[140:143]
    ds_read_b128 v[188:191], v9 offset:24576
    v_cndmask_b32 v229, v224, v226, s[96:97]
    v_mfma_f32_16x16x32_bf16 v[144:147], v[172:175], a[152:155], v[144:147]
    s_add_u32 m0, s63, 45056
    s_mul_i32 s52, s101, 13
    v_mfma_f32_16x16x32_bf16 v[148:151], a[144:147], v[176:179], v[148:151]
    ds_read_b128 v[192:195], v9 offset:28672
    buffer_load_dwordx4 v98, s[40:43], s52 offen lds
    v_mfma_f32_16x16x32_bf16 v[152:155], a[148:151], v[176:179], v[152:155]
    ds_read_b128 v[196:199], v9 offset:32768
    ds_write_b64 v60, v[228:229] offset:512
    v_mfma_f32_16x16x32_bf16 v[156:159], v[176:179], a[152:155], v[156:159]
    v_cndmask_b32 v232, v232, v233, s[56:57]
    v_cndmask_b32 v234, v234, v235, s[60:61]
    v_mfma_f32_16x16x32_bf16 v[88:91], a[148:151], v[180:183], v[88:91]
    ds_read_b128 v[200:203], v9 offset:36864
    v_cndmask_b32 v237, v232, v234, s[96:97]
    v_mfma_f32_16x16x32_bf16 v[92:95], v[180:183], a[152:155], v[92:95]
    ds_read_b128 v[204:207], v9 offset:53248
    ds_write_b64 v60, v[236:237] offset:1024
    v_mfma_f32_16x16x32_bf16 v[36:39], a[144:147], v[20:23], v[36:39]
    s_add_u32 m0, s63, 49152
    s_mul_i32 s52, s101, 14
    v_mfma_f32_16x16x32_bf16 v[40:43], a[148:151], v[20:23], v[40:43]
    buffer_load_dwordx4 v98, s[40:43], s52 offen lds
    v_mfma_f32_16x16x32_bf16 v[44:47], v[20:23], a[152:155], v[44:47]
    v_cndmask_b32 v240, v240, v241, s[56:57]
    v_cndmask_b32 v242, v242, v243, s[60:61]
    v_cndmask_b32 v245, v240, v242, s[96:97]
    ds_write_b64 v60, v[244:245] offset:1536
    v_cndmask_b32 v74, v74, v75, s[56:57]
    s_add_u32 m0, s63, 53248
    s_mul_i32 s52, s101, 15
    buffer_load_dwordx4 v98, s[40:43], s52 offen lds
    v_cndmask_b32 v76, v76, v77, s[60:61]
    v_cndmask_b32 v79, v74, v76, s[96:97]
    ds_write_b64 v60, v[78:79] offset:2048
    v_cndmask_b32 v48, v48, v49, s[56:57]
    v_cndmask_b32 v50, v50, v51, s[60:61]
    s_lshl_b32 s53, s7, 2
    s_add_u32 s53, s53, s3
    s_mul_i32 s53, s53, 5760
    s_add_u32 s53, s53, s72
    v_min_u32 v61, 44, v1
    v_lshlrev_b32 v61, 7, v61
    buffer_load_dword v254, v61, s[44:47], s53 offen sc1
    v_cndmask_b32 v53, v48, v50, s[96:97]
    ds_write_b64 v60, v[52:53] offset:2560
    s_waitcnt lgkmcnt(3)
    v_mfma_f32_16x16x32_bf16 v[100:103], a[156:159], v[184:187], v[100:103]
    s_waitcnt vmcnt(11)
    s_waitcnt lgkmcnt(0)
    s_barrier
    v_mfma_f32_16x16x32_bf16 v[104:107], a[160:163], v[184:187], v[104:107]
    ds_read_b128 v[208:211], v63
    v_mfma_f32_16x16x32_bf16 v[108:111], v[184:187], a[164:167], v[108:111]
    ds_read_b128 v[212:215], v63 offset:16
    v_mfma_f32_16x16x32_bf16 v[112:115], a[156:159], v[188:191], v[112:115]
    ds_read_b128 v[160:163], v10 offset:20480
    v_mfma_f32_16x16x32_bf16 v[116:119], a[160:163], v[188:191], v[116:119]
    ds_read_b64_tr_b16 a[168:169], v19 offset:49152
    v_mfma_f32_16x16x32_bf16 v[120:123], v[188:191], a[164:167], v[120:123]
    ds_read_b64_tr_b16 a[170:171], v19 offset:49664
    s_waitcnt lgkmcnt(4)
    v_add_f32 v208, v208, v210
    v_mfma_f32_16x16x32_bf16 v[124:127], a[156:159], v[192:195], v[124:127]
    v_add_f32 v209, v209, v211
    s_waitcnt lgkmcnt(3)
    v_add_f32 v212, v212, v214
    v_mfma_f32_16x16x32_bf16 v[128:131], a[160:163], v[192:195], v[128:131]
    ds_read_b64_tr_b16 a[172:173], v19 offset:50176
    v_add_f32 v213, v213, v215
    v_mfma_f32_16x16x32_bf16 v[132:135], v[192:195], a[164:167], v[132:135]
    ds_read_b64_tr_b16 a[174:175], v19 offset:50688
    v_add_f32 v208, v208, v212
    v_mfma_f32_16x16x32_bf16 v[136:139], a[156:159], v[196:199], v[136:139]
    ds_read_b64_tr_b16 a[176:177], v19 offset:51200
    v_add_f32 v209, v209, v213
    v_mfma_f32_16x16x32_bf16 v[140:143], a[160:163], v[196:199], v[140:143]
    ds_read_b64_tr_b16 a[178:179], v19 offset:51712
    v_mul_f32 v210, 0x3b000000, v208
    v_mfma_f32_16x16x32_bf16 v[144:147], v[196:199], a[164:167], v[144:147]
    ds_read_b128 v[164:167], v10 offset:24576
    v_mul_f32 v211, 0x3b000000, v209
    v_mfma_f32_16x16x32_bf16 v[148:151], a[156:159], v[200:203], v[148:151]
    v_fma_f32 v211, -v210, v210, v211
    v_max_f32 v211, 0, v211
    v_mfma_f32_16x16x32_bf16 v[152:155], a[160:163], v[200:203], v[152:155]
    ds_read_b128 v[168:171], v10 offset:28672
    v_cvt_pk_bf16_f32 v213, v211, v211
    v_mfma_f32_16x16x32_bf16 v[156:159], v[200:203], a[164:167], v[156:159]
    ds_read_b128 v[172:175], v10 offset:32768
    v_lshlrev_b32 v213, 16, v213
    v_mfma_f32_16x16x32_bf16 v[88:91], a[160:163], v[204:207], v[88:91]
    ds_read_b128 v[176:179], v10 offset:36864
    v_add_f32 v213, 0x3727c5ac, v213
    v_mfma_f32_16x16x32_bf16 v[92:95], v[204:207], a[164:167], v[92:95]
    ds_read_b128 v[180:183], v10 offset:53248
    v_cvt_pk_bf16_f32 v213, v213, v213
    v_mfma_f32_16x16x32_bf16 v[36:39], a[156:159], v[20:23], v[36:39]
    v_lshlrev_b32 v213, 16, v213
    v_sqrt_f32 v213, v213
    v_mfma_f32_16x16x32_bf16 v[40:43], a[160:163], v[20:23], v[40:43]
    v_cvt_pk_bf16_f32 v212, v210, v210
    v_cvt_pk_bf16_f32 v213, v213, v213
    v_mfma_f32_16x16x32_bf16 v[44:47], v[20:23], a[164:167], v[44:47]
    v_lshlrev_b32 v213, 16, v213
    v_rcp_f32 v213, v213
    v_lshlrev_b32 v212, 16, v212
    v_sub_f32 v212, 0, v212
    ds_write2_b32 v62, v213, v212 offset0:0 offset1:96
    s_waitcnt lgkmcnt(5)
    v_mfma_f32_16x16x32_bf16 v[100:103], a[168:171], v[160:163], v[100:103]
    s_waitcnt vmcnt(6)
    s_waitcnt lgkmcnt(0)
    s_barrier
    v_mfma_f32_16x16x32_bf16 v[104:107], a[172:175], v[160:163], v[104:107]
    ds_read_b128 v[184:187], v11 offset:20480
    ds_read_b64_tr_b16 a[180:181], v19 offset:0
    v_mfma_f32_16x16x32_bf16 v[108:111], v[160:163], a[176:179], v[108:111]
    ds_read_b64_tr_b16 a[182:183], v19 offset:512
    v_mfma_f32_16x16x32_bf16 v[112:115], a[168:171], v[164:167], v[112:115]
    ds_read_b64_tr_b16 a[184:185], v19 offset:1024
    ds_read_b64_tr_b16 a[186:187], v19 offset:1536
    v_mfma_f32_16x16x32_bf16 v[116:119], a[172:175], v[164:167], v[116:119]
    ds_read_b64_tr_b16 a[188:189], v19 offset:2048
    v_mfma_f32_16x16x32_bf16 v[120:123], v[164:167], a[176:179], v[120:123]
    ds_read_b64_tr_b16 a[190:191], v19 offset:2560
    ds_read_b128 v[188:191], v11 offset:24576
    v_mfma_f32_16x16x32_bf16 v[124:127], a[168:171], v[168:171], v[124:127]
    ds_read_b128 v[192:195], v11 offset:28672
    v_mfma_f32_16x16x32_bf16 v[128:131], a[172:175], v[168:171], v[128:131]
    ds_read_b128 v[196:199], v11 offset:32768
    v_mfma_f32_16x16x32_bf16 v[132:135], v[168:171], a[176:179], v[132:135]
    ds_read_b128 v[200:203], v11 offset:36864
    ds_read_b128 v[204:207], v11 offset:53248
    v_mfma_f32_16x16x32_bf16 v[136:139], a[168:171], v[172:175], v[136:139]
    ds_read2_b32 v[208:209], v252 offset0:0 offset1:96
    v_mfma_f32_16x16x32_bf16 v[140:143], a[172:175], v[172:175], v[140:143]
    ds_read_b128 v[210:213], v253 offset:0
    ds_read_b128 v[214:217], v253 offset:384
    v_mfma_f32_16x16x32_bf16 v[144:147], v[172:175], a[176:179], v[144:147]
    ds_read2_b32 v[218:219], v252 offset0:16 offset1:112
    v_mfma_f32_16x16x32_bf16 v[148:151], a[168:171], v[176:179], v[148:151]
    ds_read_b128 v[220:223], v253 offset:64
    v_mfma_f32_16x16x32_bf16 v[152:155], a[172:175], v[176:179], v[152:155]
    ds_read_b128 v[224:227], v253 offset:448
    ds_read2_b32 v[228:229], v252 offset0:32 offset1:128
    v_mfma_f32_16x16x32_bf16 v[156:159], v[176:179], a[176:179], v[156:159]
    ds_read_b128 v[230:233], v253 offset:128
    v_mfma_f32_16x16x32_bf16 v[88:91], a[172:175], v[180:183], v[88:91]
    ds_read_b128 v[234:237], v253 offset:512
    v_mfma_f32_16x16x32_bf16 v[92:95], v[180:183], a[176:179], v[92:95]
    ds_read2_b32 v[238:239], v252 offset0:48 offset1:144
    v_mfma_f32_16x16x32_bf16 v[36:39], a[168:171], v[20:23], v[36:39]
    ds_read_b128 v[240:243], v253 offset:192
    v_mfma_f32_16x16x32_bf16 v[40:43], a[172:175], v[20:23], v[40:43]
    ds_read_b128 v[244:247], v253 offset:576
    v_mfma_f32_16x16x32_bf16 v[44:47], v[20:23], a[176:179], v[44:47]
    s_waitcnt lgkmcnt(15)
    v_mfma_f32_16x16x32_bf16 v[100:103], a[180:183], v[184:187], v[100:103]
    v_mfma_f32_16x16x32_bf16 v[104:107], a[184:187], v[184:187], v[104:107]
    ds_read2_b32 v[170:171], v252 offset0:80 offset1:176
    v_mul_u32_u24 v48, 144, v3
    v_mfma_f32_16x16x32_bf16 v[108:111], v[184:187], a[188:191], v[108:111]
    v_lshl_add_u32 v48, v2, 3, v48
    s_lshl_b32 s52, s3, 5
    v_mfma_f32_16x16x32_bf16 v[112:115], a[180:183], v[188:191], v[112:115]
    ds_read_b128 v[172:175], v253 offset:320
    s_add_u32 s52, s52, s12
    v_mfma_f32_16x16x32_bf16 v[116:119], a[184:187], v[188:191], v[116:119]
    v_add_u32 v48, s52, v48
    v_lshrrev_b32 v49, 3, v0
    v_mfma_f32_16x16x32_bf16 v[120:123], v[188:191], a[188:191], v[120:123]
    v_and_b32 v50, 7, v0
    v_lshlrev_b32 v50, 4, v50
    v_mfma_f32_16x16x32_bf16 v[124:127], a[180:183], v[192:195], v[124:127]
    ds_read_b128 v[176:179], v253 offset:704
    v_mul_u32_u24 v51, 144, v49
    v_mfma_f32_16x16x32_bf16 v[128:131], a[184:187], v[192:195], v[128:131]
    v_add3_u32 v51, v51, v50, s12
    v_lshl_add_u32 v49, v49, 10, v50
    v_mfma_f32_16x16x32_bf16 v[132:135], v[192:195], a[188:191], v[132:135]
    s_lshl_b32 s53, s7, 7
    s_waitcnt lgkmcnt(4)
    v_mfma_f32_16x16x32_bf16 v[136:139], a[180:183], v[196:199], v[136:139]
    ds_read2_b32 v[160:161], v252 offset0:64 offset1:160
    s_add_u32 s53, s53, s72
    v_mfma_f32_16x16x32_bf16 v[140:143], a[184:187], v[196:199], v[140:143]
    s_add_u32 s54, s53, 32768
    v_mfma_f32_16x16x32_bf16 v[144:147], v[196:199], a[188:191], v[144:147]
    s_add_u32 s55, s53, 49152
    v_mfma_f32_16x16x32_bf16 v[148:151], a[180:183], v[200:203], v[148:151]
    ds_read_b128 v[162:165], v253 offset:256
    s_mov_b32 s85, s72
    v_mfma_f32_16x16x32_bf16 v[152:155], a[184:187], v[200:203], v[152:155]
    s_add_u32 s84, s72, 174080
    v_mfma_f32_16x16x32_bf16 v[156:159], v[200:203], a[188:191], v[156:159]
    v_mov_b32 v52, s90
    v_mfma_f32_16x16x32_bf16 v[88:91], a[184:187], v[204:207], v[88:91]
    ds_read_b128 v[166:169], v253 offset:640
    v_mov_b32 v53, s65
    v_mfma_f32_16x16x32_bf16 v[92:95], v[204:207], a[188:191], v[92:95]
    v_mfma_f32_16x16x32_bf16 v[36:39], a[180:183], v[20:23], v[36:39]
    v_mfma_f32_16x16x32_bf16 v[40:43], a[184:187], v[20:23], v[40:43]
    v_mfma_f32_16x16x32_bf16 v[44:47], v[20:23], a[188:191], v[44:47]
    s_waitcnt lgkmcnt(3)
    s_nop 5
    v_pk_fma_f32 v[88:89], v[40:41], v[170:171], v[88:89] op_sel:[0,1,0] op_sel_hi:[1,1,1]
    v_pk_fma_f32 v[90:91], v[42:43], v[170:171], v[90:91] op_sel:[0,1,0] op_sel_hi:[1,1,1]
    v_pk_fma_f32 v[92:93], v[176:177], v[44:45], v[92:93] op_sel_hi:[1,0,1]
    v_pk_fma_f32 v[94:95], v[178:179], v[44:45], v[94:95] op_sel_hi:[1,0,1]
    v_pk_mul_f32 v[88:89], v[88:89], v[170:171] op_sel_hi:[1,0]
    v_pk_mul_f32 v[90:91], v[90:91], v[170:171] op_sel_hi:[1,0]
    v_pk_mul_f32 v[92:93], v[92:93], v[172:173]
    v_pk_mul_f32 v[94:95], v[94:95], v[174:175]
    v_cvt_pk_bf16_f32 v180, v88, v89
    v_cvt_pk_bf16_f32 v181, v90, v91
    v_cvt_pk_bf16_f32 v86, v92, v93
    v_cvt_pk_bf16_f32 v87, v94, v95
    s_waitcnt vmcnt(5)
    v_cmp_ne_u32 vcc, s90, v59
    s_nop 0
    s_cmp_eq_u64 vcc, 0
    s_waitcnt lgkmcnt(0)
    s_nop 0
    s_cbranch_scc1 Lxc_3
    s_mov_b32 s95, 0x200000
Lp_4:
    buffer_load_dwordx2 v[58:59], v64, s[44:47], s66 offen sc1
    s_waitcnt vmcnt(0)
    v_cmp_ne_u32 vcc, s90, v59
    s_nop 0
    s_cmp_eq_u64 vcc, 0
    s_nop 1
    s_cbranch_scc1 Ld_5
    s_sub_u32 s95, s95, 1
    s_cmp_lg_u32 s95, 0
    s_cbranch_scc1 Lp_4
    s_branch L_abort
Ld_5:
Lxc_3:
    v_cmp_ne_u32 vcc, s81, v58
    s_nop 0
    s_cmp_eq_u64 vcc, 0
    s_cselect_b32 s91, 1, 0
    s_cmp_eq_u32 s91, 1
    s_cselect_b64 s[28:29], -1, 0
    s_cselect_b64 s[16:17], 0, -1
    v_pk_fma_f32 v[100:101], v[36:37], v[208:209], v[100:101] op_sel:[0,1,0] op_sel_hi:[1,1,1]
    v_pk_fma_f32 v[112:113], v[36:37], v[218:219], v[112:113] op_sel:[0,1,0] op_sel_hi:[1,1,1]
    v_pk_fma_f32 v[124:125], v[36:37], v[228:229], v[124:125] op_sel:[0,1,0] op_sel_hi:[1,1,1]
    v_pk_fma_f32 v[136:137], v[36:37], v[238:239], v[136:137] op_sel:[0,1,0] op_sel_hi:[1,1,1]
    v_pk_fma_f32 v[148:149], v[36:37], v[160:161], v[148:149] op_sel:[0,1,0] op_sel_hi:[1,1,1]
    v_pk_fma_f32 v[102:103], v[38:39], v[208:209], v[102:103] op_sel:[0,1,0] op_sel_hi:[1,1,1]
    v_pk_fma_f32 v[114:115], v[38:39], v[218:219], v[114:115] op_sel:[0,1,0] op_sel_hi:[1,1,1]
    v_pk_fma_f32 v[126:127], v[38:39], v[228:229], v[126:127] op_sel:[0,1,0] op_sel_hi:[1,1,1]
    v_pk_fma_f32 v[138:139], v[38:39], v[238:239], v[138:139] op_sel:[0,1,0] op_sel_hi:[1,1,1]
    v_pk_fma_f32 v[150:151], v[38:39], v[160:161], v[150:151] op_sel:[0,1,0] op_sel_hi:[1,1,1]
    v_pk_fma_f32 v[104:105], v[40:41], v[208:209], v[104:105] op_sel:[0,1,0] op_sel_hi:[1,1,1]
    v_pk_fma_f32 v[116:117], v[40:41], v[218:219], v[116:117] op_sel:[0,1,0] op_sel_hi:[1,1,1]
    v_pk_fma_f32 v[128:129], v[40:41], v[228:229], v[128:129] op_sel:[0,1,0] op_sel_hi:[1,1,1]
    v_pk_fma_f32 v[140:141], v[40:41], v[238:239], v[140:141] op_sel:[0,1,0] op_sel_hi:[1,1,1]
    v_pk_fma_f32 v[152:153], v[40:41], v[160:161], v[152:153] op_sel:[0,1,0] op_sel_hi:[1,1,1]
    v_pk_fma_f32 v[106:107], v[42:43], v[208:209], v[106:107] op_sel:[0,1,0] op_sel_hi:[1,1,1]
    v_pk_fma_f32 v[118:119], v[42:43], v[218:219], v[118:119] op_sel:[0,1,0] op_sel_hi:[1,1,1]
    v_pk_fma_f32 v[130:131], v[42:43], v[228:229], v[130:131] op_sel:[0,1,0] op_sel_hi:[1,1,1]
    v_pk_fma_f32 v[142:143], v[42:43], v[238:239], v[142:143] op_sel:[0,1,0] op_sel_hi:[1,1,1]
    v_pk_fma_f32 v[154:155], v[42:43], v[160:161], v[154:155] op_sel:[0,1,0] op_sel_hi:[1,1,1]
    v_pk_mul_f32 v[104:105], v[104:105], v[208:209] op_sel_hi:[1,0]
    v_pk_mul_f32 v[116:117], v[116:117], v[218:219] op_sel_hi:[1,0]
    v_pk_mul_f32 v[128:129], v[128:129], v[228:229] op_sel_hi:[1,0]
    v_pk_mul_f32 v[140:141], v[140:141], v[238:239] op_sel_hi:[1,0]
    v_pk_mul_f32 v[152:153], v[152:153], v[160:161] op_sel_hi:[1,0]
    v_pk_mul_f32 v[106:107], v[106:107], v[208:209] op_sel_hi:[1,0]
    v_pk_mul_f32 v[118:119], v[118:119], v[218:219] op_sel_hi:[1,0]
    v_pk_mul_f32 v[130:131], v[130:131], v[228:229] op_sel_hi:[1,0]
    v_pk_mul_f32 v[142:143], v[142:143], v[238:239] op_sel_hi:[1,0]
    v_pk_mul_f32 v[154:155], v[154:155], v[160:161] op_sel_hi:[1,0]
    v_cvt_pk_bf16_f32 v170, v100, v101
    v_cvt_pk_bf16_f32 v172, v112, v113
    v_cvt_pk_bf16_f32 v174, v124, v125
    v_cvt_pk_bf16_f32 v176, v136, v137
    v_cvt_pk_bf16_f32 v178, v148, v149
    v_cvt_pk_bf16_f32 v171, v102, v103
    v_cvt_pk_bf16_f32 v173, v114, v115
    v_cvt_pk_bf16_f32 v175, v126, v127
    v_cvt_pk_bf16_f32 v177, v138, v139
    v_cvt_pk_bf16_f32 v179, v150, v151
    v_cvt_pk_bf16_f32 v182, v104, v105
    v_cvt_pk_bf16_f32 v184, v116, v117
    v_cvt_pk_bf16_f32 v186, v128, v129
    v_cvt_pk_bf16_f32 v188, v140, v141
    v_cvt_pk_bf16_f32 v190, v152, v153
    v_cvt_pk_bf16_f32 v183, v106, v107
    v_cvt_pk_bf16_f32 v185, v118, v119
    v_cvt_pk_bf16_f32 v187, v130, v131
    v_cvt_pk_bf16_f32 v189, v142, v143
    v_cvt_pk_bf16_f32 v191, v154, v155
    v_pk_fma_f32 v[108:109], v[214:215], v[44:45], v[108:109] op_sel_hi:[1,0,1]
    v_pk_fma_f32 v[120:121], v[224:225], v[44:45], v[120:121] op_sel_hi:[1,0,1]
    v_pk_fma_f32 v[132:133], v[234:235], v[44:45], v[132:133] op_sel_hi:[1,0,1]
    v_pk_fma_f32 v[144:145], v[244:245], v[44:45], v[144:145] op_sel_hi:[1,0,1]
    v_pk_fma_f32 v[156:157], v[166:167], v[44:45], v[156:157] op_sel_hi:[1,0,1]
    v_pk_fma_f32 v[110:111], v[216:217], v[44:45], v[110:111] op_sel_hi:[1,0,1]
    v_pk_fma_f32 v[122:123], v[226:227], v[44:45], v[122:123] op_sel_hi:[1,0,1]
    v_pk_fma_f32 v[134:135], v[236:237], v[44:45], v[134:135] op_sel_hi:[1,0,1]
    v_pk_fma_f32 v[146:147], v[246:247], v[44:45], v[146:147] op_sel_hi:[1,0,1]
    v_pk_fma_f32 v[158:159], v[168:169], v[44:45], v[158:159] op_sel_hi:[1,0,1]
    v_pk_mul_f32 v[108:109], v[108:109], v[210:211]
    v_pk_mul_f32 v[120:121], v[120:121], v[220:221]
    v_pk_mul_f32 v[132:133], v[132:133], v[230:231]
    v_pk_mul_f32 v[144:145], v[144:145], v[240:241]
    v_pk_mul_f32 v[156:157], v[156:157], v[162:163]
    v_pk_mul_f32 v[110:111], v[110:111], v[212:213]
    v_pk_mul_f32 v[122:123], v[122:123], v[222:223]
    v_pk_mul_f32 v[134:135], v[134:135], v[232:233]
    v_pk_mul_f32 v[146:147], v[146:147], v[242:243]
    v_pk_mul_f32 v[158:159], v[158:159], v[164:165]
    v_mfma_f32_16x16x16_bf16 v[100:103], v[180:181], v[170:171], v[32:35]
    v_cvt_pk_bf16_f32 v88, v108, v109
    v_cvt_pk_bf16_f32 v89, v110, v111
    v_mfma_f32_16x16x16_bf16 v[104:107], v[182:183], v[170:171], v[24:27]
    v_mul_f32 v192, s79, v208
    v_mfma_f32_16x16x16_bf16 v[112:115], v[182:183], v[172:173], v[28:31]
    v_cvt_pk_bf16_f32 v90, v120, v121
    v_cvt_pk_bf16_f32 v91, v122, v123
    v_mfma_f32_16x16x16_bf16 v[116:119], v[184:185], v[172:173], v[24:27]
    v_mul_f32 v194, s79, v218
    v_mfma_f32_16x16x16_bf16 v[124:127], v[184:185], v[174:175], v[28:31]
    v_cvt_pk_bf16_f32 v92, v132, v133
    v_cvt_pk_bf16_f32 v93, v134, v135
    v_mfma_f32_16x16x16_bf16 v[128:131], v[186:187], v[174:175], v[24:27]
    v_mul_f32 v196, s79, v228
    v_mfma_f32_16x16x16_bf16 v[136:139], v[186:187], v[176:177], v[28:31]
    v_cvt_pk_bf16_f32 v94, v144, v145
    v_cvt_pk_bf16_f32 v95, v146, v147
    v_mfma_f32_16x16x16_bf16 v[140:143], v[188:189], v[176:177], v[24:27]
    v_mul_f32 v198, s79, v238
    v_mfma_f32_16x16x16_bf16 v[148:151], v[188:189], v[178:179], v[28:31]
    v_cvt_pk_bf16_f32 v96, v156, v157
    v_cvt_pk_bf16_f32 v97, v158, v159
    v_mfma_f32_16x16x16_bf16 v[152:155], v[190:191], v[178:179], v[24:27]
    v_mul_f32 v200, s79, v160
    v_max_f32 v100, v100, v104
    v_max_f32 v112, v112, v116
    v_max_f32 v124, v124, v128
    v_max_f32 v136, v136, v140
    s_nop 2
    v_max_f32 v148, v148, v152
    v_max_f32 v101, v101, v105
    v_max_f32 v113, v113, v117
    v_max_f32 v125, v125, v129
    v_max_f32 v137, v137, v141
    v_max_f32 v149, v149, v153
    v_max_f32 v102, v102, v106
    v_max_f32 v114, v114, v118
    v_max_f32 v126, v126, v130
    v_max_f32 v138, v138, v142
    v_max_f32 v150, v150, v154
    v_max_f32 v103, v103, v107
    v_max_f32 v115, v115, v119
    v_max_f32 v127, v127, v131
    v_max_f32 v139, v139, v143
    v_max_f32 v151, v151, v155
    v_max3_f32 v202, v100, v101, v102
    v_max3_f32 v203, v112, v113, v114
    v_max3_f32 v204, v124, v125, v126
    v_max3_f32 v205, v136, v137, v138
    v_max3_f32 v206, v148, v149, v150
    v_max_f32 v202, v202, v103
    v_max_f32 v203, v203, v115
    v_max_f32 v204, v204, v127
    v_max_f32 v205, v205, v139
    v_max_f32 v206, v206, v151
    v_mov_b32 v207, v206
    v_permlane16_swap_b32 v202, v203
    v_permlane16_swap_b32 v204, v205
    v_permlane16_swap_b32 v206, v207
    v_max_f32 v202, v202, v203
    v_max_f32 v204, v204, v205
    v_max_f32 v206, v206, v207
    v_mov_b32 v207, v206
    v_permlane32_swap_b32 v202, v204
    s_nop 0
    v_permlane32_swap_b32 v206, v207
    v_max_f32 v202, v202, v204
    v_max_f32 v206, v206, v207
    v_mov_b32 v204, v202
    v_mul_f32 v201, v206, v200
    s_nop 0
    v_permlane32_swap_b32 v202, v204
    v_mov_b32 v203, v202
    v_mov_b32 v205, v204
    s_nop 0
    v_permlane16_swap_b32 v202, v203
    v_permlane16_swap_b32 v204, v205
    v_pk_fma_f32 v[148:149], v[148:149], v[200:201], v[200:201] op_sel:[0,0,1] op_sel_hi:[1,0,1] neg_lo:[0,0,1] neg_hi:[0,0,1]
    v_mul_f32 v193, v202, v192
    v_mul_f32 v195, v203, v194
    v_mul_f32 v197, v204, v196
    v_mul_f32 v199, v205, v198
    v_pk_fma_f32 v[150:151], v[150:151], v[200:201], v[200:201] op_sel:[0,0,1] op_sel_hi:[1,0,1] neg_lo:[0,0,1] neg_hi:[0,0,1]
    v_pk_fma_f32 v[100:101], v[100:101], v[192:193], v[192:193] op_sel:[0,0,1] op_sel_hi:[1,0,1] neg_lo:[0,0,1] neg_hi:[0,0,1]
    v_pk_fma_f32 v[112:113], v[112:113], v[194:195], v[194:195] op_sel:[0,0,1] op_sel_hi:[1,0,1] neg_lo:[0,0,1] neg_hi:[0,0,1]
    v_pk_fma_f32 v[124:125], v[124:125], v[196:197], v[196:197] op_sel:[0,0,1] op_sel_hi:[1,0,1] neg_lo:[0,0,1] neg_hi:[0,0,1]
    v_pk_fma_f32 v[136:137], v[136:137], v[198:199], v[198:199] op_sel:[0,0,1] op_sel_hi:[1,0,1] neg_lo:[0,0,1] neg_hi:[0,0,1]
    v_pk_fma_f32 v[102:103], v[102:103], v[192:193], v[192:193] op_sel:[0,0,1] op_sel_hi:[1,0,1] neg_lo:[0,0,1] neg_hi:[0,0,1]
    v_pk_fma_f32 v[114:115], v[114:115], v[194:195], v[194:195] op_sel:[0,0,1] op_sel_hi:[1,0,1] neg_lo:[0,0,1] neg_hi:[0,0,1]
    v_pk_fma_f32 v[126:127], v[126:127], v[196:197], v[196:197] op_sel:[0,0,1] op_sel_hi:[1,0,1] neg_lo:[0,0,1] neg_hi:[0,0,1]
    v_pk_fma_f32 v[138:139], v[138:139], v[198:199], v[198:199] op_sel:[0,0,1] op_sel_hi:[1,0,1] neg_lo:[0,0,1] neg_hi:[0,0,1]
    v_exp_f32 v100, v100
    v_exp_f32 v112, v112
    v_exp_f32 v101, v101
    v_exp_f32 v113, v113
    v_exp_f32 v102, v102
    v_exp_f32 v114, v114
    v_exp_f32 v103, v103
    v_exp_f32 v115, v115
    v_cvt_pk_bf16_f32 v100, v100, v101
    v_cvt_pk_bf16_f32 v112, v112, v113
    v_cvt_pk_bf16_f32 v101, v102, v103
    v_cvt_pk_bf16_f32 v113, v114, v115
    v_and_b32 v104, v248, v100
    v_and_b32 v116, v248, v112
    v_and_b32 v105, v249, v101
    v_and_b32 v117, v249, v113
    v_and_b32 v106, v250, v100
    v_and_b32 v118, v250, v112
    v_and_b32 v107, v251, v101
    v_and_b32 v119, v251, v113
    v_mfma_f32_16x16x16_bf16 v[210:213], v[20:21], v[100:101], 0
    v_mfma_f32_16x16x16_bf16 v[220:223], v[20:21], v[112:113], 0
    v_mfma_f32_16x16x32_bf16 v[108:111], v[86:89], v[104:107], 0
    v_mfma_f32_16x16x32_bf16 v[120:123], v[88:91], v[116:119], 0
    v_exp_f32 v124, v124
    v_exp_f32 v136, v136
    v_exp_f32 v125, v125
    v_exp_f32 v137, v137
    v_exp_f32 v126, v126
    v_exp_f32 v138, v138
    v_exp_f32 v127, v127
    v_exp_f32 v139, v139
    v_cvt_pk_bf16_f32 v124, v124, v125
    v_cvt_pk_bf16_f32 v136, v136, v137
    v_cvt_pk_bf16_f32 v125, v126, v127
    v_cvt_pk_bf16_f32 v137, v138, v139
    v_and_b32 v128, v248, v124
    v_and_b32 v140, v248, v136
    v_and_b32 v129, v249, v125
    v_and_b32 v141, v249, v137
    v_and_b32 v130, v250, v124
    v_and_b32 v142, v250, v136
    v_and_b32 v131, v251, v125
    v_and_b32 v143, v251, v137
    v_mfma_f32_16x16x16_bf16 v[230:233], v[20:21], v[124:125], 0
    v_mfma_f32_16x16x16_bf16 v[240:243], v[20:21], v[136:137], 0
    v_mfma_f32_16x16x32_bf16 v[132:135], v[90:93], v[128:131], 0
    v_mfma_f32_16x16x32_bf16 v[144:147], v[92:95], v[140:143], 0
    v_exp_f32 v148, v148
    v_rcp_f32 v210, v210
    v_rcp_f32 v220, v220
    v_exp_f32 v149, v149
    v_mul_f32 v108, v108, v210
    v_mul_f32 v120, v120, v220
    v_exp_f32 v150, v150
    v_mul_f32 v109, v109, v210
    v_mul_f32 v121, v121, v220
    v_exp_f32 v151, v151
    v_mul_f32 v110, v110, v210
    v_mul_f32 v122, v122, v220
    v_cvt_pk_bf16_f32 v148, v148, v149
    v_mul_f32 v111, v111, v210
    v_mul_f32 v123, v123, v220
    v_cvt_pk_bf16_f32 v149, v150, v151
    v_cvt_pk_bf16_f32 v170, v108, v109
    v_cvt_pk_bf16_f32 v172, v120, v121
    v_and_b32 v152, v248, v148
    v_cvt_pk_bf16_f32 v171, v110, v111
    v_cvt_pk_bf16_f32 v173, v122, v123
    v_and_b32 v153, v249, v149
    ds_write_b64 v48, v[170:171] offset:0
    ds_write_b64 v48, v[172:173] offset:2304
    v_and_b32 v154, v250, v148
    v_and_b32 v155, v251, v149
    v_mfma_f32_16x16x16_bf16 v[162:165], v[20:21], v[148:149], 0
    s_nop 0
    v_mfma_f32_16x16x32_bf16 v[156:159], v[94:97], v[152:155], 0
    v_rcp_f32 v230, v230
    v_rcp_f32 v240, v240
    s_nop 3
    v_rcp_f32 v162, v162
    v_mul_f32 v132, v132, v230
    v_mul_f32 v144, v144, v240
    v_mul_f32 v156, v156, v162
    v_mul_f32 v133, v133, v230
    v_mul_f32 v145, v145, v240
    v_mul_f32 v157, v157, v162
    v_mul_f32 v134, v134, v230
    v_mul_f32 v146, v146, v240
    v_mul_f32 v158, v158, v162
    v_mul_f32 v135, v135, v230
    v_mul_f32 v147, v147, v240
    v_mul_f32 v159, v159, v162
    v_cvt_pk_bf16_f32 v174, v132, v133
    v_cvt_pk_bf16_f32 v176, v144, v145
    v_cvt_pk_bf16_f32 v178, v156, v157
    v_cvt_pk_bf16_f32 v175, v134, v135
    v_cvt_pk_bf16_f32 v177, v146, v147
    v_cvt_pk_bf16_f32 v179, v158, v159
    ds_write_b64 v48, v[174:175] offset:4608
    ds_write_b64 v48, v[176:177] offset:6912
    ds_write_b64 v48, v[178:179] offset:9216
    s_waitcnt vmcnt(1)
    s_waitcnt lgkmcnt(0)
    s_barrier
    ds_read_b128 v[224:227], v51 offset:0
    ds_read_b128 v[228:231], v51 offset:4608
    ds_read_b128 v[232:235], v51 offset:6912
    s_waitcnt lgkmcnt(0)
    s_cmp_eq_u32 s91, 1
    s_cbranch_scc0 Ls_6
    buffer_store_dwordx4 v[224:227], v49, s[44:47], s53 offen
    buffer_store_dwordx4 v[228:231], v49, s[44:47], s54 offen
    buffer_store_dwordx4 v[232:235], v49, s[44:47], s55 offen
    s_nop 0
    s_branch Le_7
Ls_6:
    buffer_store_dwordx4 v[224:227], v49, s[44:47], s53 offen sc1
    buffer_store_dwordx4 v[228:231], v49, s[44:47], s54 offen sc1
    buffer_store_dwordx4 v[232:235], v49, s[44:47], s55 offen sc1
Le_7:
    v_add_u32 v161, 81920, v82
    ds_read_b64_tr_b16 a[192:193], v82 offset:0
    ds_read_b64_tr_b16 a[194:195], v82 offset:512
    ds_read_b64_tr_b16 a[196:197], v82 offset:4096
    ds_read_b64_tr_b16 a[198:199], v82 offset:4608
    ds_read_b64_tr_b16 a[200:201], v82 offset:8192
    ds_read_b64_tr_b16 a[202:203], v82 offset:8704
    ds_read_b64_tr_b16 a[204:205], v82 offset:12288
    ds_read_b64_tr_b16 a[206:207], v82 offset:12800
    ds_read_b64_tr_b16 a[208:209], v82 offset:16384
    ds_read_b64_tr_b16 a[210:211], v82 offset:16896
    ds_read_b64_tr_b16 a[212:213], v161 offset:0
    ds_read_b64_tr_b16 a[214:215], v161 offset:512
    ds_read_b64_tr_b16 a[216:217], v82 offset:20480
    ds_read_b64_tr_b16 a[218:219], v82 offset:20992
    ds_read_b64_tr_b16 a[220:221], v82 offset:24576
    ds_read_b64_tr_b16 a[222:223], v82 offset:25088
    ds_read_b64_tr_b16 a[224:225], v82 offset:28672
    ds_read_b64_tr_b16 a[226:227], v82 offset:29184
    ds_read_b64_tr_b16 a[228:229], v82 offset:32768
    ds_read_b64_tr_b16 a[230:231], v82 offset:33280
    ds_read_b64_tr_b16 a[232:233], v82 offset:36864
    ds_read_b64_tr_b16 a[234:235], v82 offset:37376
    ds_read_b64_tr_b16 a[236:237], v161 offset:4096
    ds_read_b64_tr_b16 a[238:239], v161 offset:4608
    ds_read_b64_tr_b16 a[240:241], v82 offset:40960
    ds_read_b64_tr_b16 a[242:243], v82 offset:41472
    ds_read_b64_tr_b16 a[244:245], v82 offset:45056
    ds_read_b64_tr_b16 a[246:247], v82 offset:45568
    ds_read_b64_tr_b16 a[248:249], v82 offset:49152
    ds_read_b64_tr_b16 a[250:251], v82 offset:49664
    ds_read_b64_tr_b16 a[252:253], v82 offset:53248
    ds_read_b64_tr_b16 a[254:255], v82 offset:53760
    s_add_u32 s52, s69, 131072
    v_add_u32 v160, s52, v18
    v_min_u32 v160, 2097144, v160
    s_waitcnt vmcnt(0)
    s_mov_b64 exec, s[28:29]
    buffer_store_dword v52, v53, s[44:47], s84 offen
    s_mov_b64 exec, s[16:17]
    buffer_store_dword v52, v53, s[44:47], s84 offen sc1
    s_mov_b64 exec, -1
    s_add_u32 s52, s69, 0
    buffer_load_dwordx2 v[72:73], v18, s[32:35], s52 offen
    s_add_u32 s52, s69, 32768
    buffer_load_dwordx2 v[74:75], v18, s[32:35], s52 offen
    s_add_u32 s52, s69, 65536
    buffer_load_dwordx2 v[76:77], v18, s[32:35], s52 offen
    s_add_u32 s52, s69, 98304
    buffer_load_dwordx2 v[78:79], v18, s[32:35], s52 offen
    buffer_load_dwordx2 v[80:81], v160, s[32:35], 0 offen
    v_mov_b32 v163, 0
    v_dot2_f32_bf16 v163, v68, s78, v163
    v_dot2_f32_bf16 v163, v69, s78, v163
    v_dot2_f32_bf16 v163, v70, s78, v163
    v_dot2_f32_bf16 v163, v71, s78, v163
    v_cmp_eq_u32 vcc, 1, v3
    s_nop 1
    v_cndmask_b32 v48, 0, v66, vcc
    v_cndmask_b32 v49, 0, v67, vcc
    v_cmp_eq_u32 vcc, 0, v3
    s_nop 1
    v_cndmask_b32 v48, v48, v20, vcc
    v_cndmask_b32 v49, v49, v20, vcc
    v_cmp_eq_u32 vcc, 2, v3
    s_nop 1
    v_cndmask_b32 v50, 0, v20, vcc
    v_cndmask_b32 v51, 0, v20, vcc
    v_add_f32_dpp v163, v163, v163 quad_perm:[1,0,3,2] row_mask:0xf bank_mask:0xf
    s_nop 1
    v_add_f32_dpp v163, v163, v163 quad_perm:[2,3,0,1] row_mask:0xf bank_mask:0xf
    s_nop 1
    v_add_f32_dpp v163, v163, v163 row_half_mirror row_mask:0xf bank_mask:0xf
    s_nop 1
    v_add_f32_dpp v163, v163, v163 row_mirror row_mask:0xf bank_mask:0xf
    v_mov_b32 v164, v163
    s_nop 1
    v_permlane16_swap_b32 v163, v164
    v_add_f32 v163, v163, v164
    v_mov_b32 v164, v163
    s_nop 1
    v_permlane32_swap_b32 v163, v164
    v_add_f32 v163, v163, v164
    s_nop 0
    v_readfirstlane_b32 s93, v163
    v_mov_b32 v32, 4284592614
    v_mov_b32 v33, 4284592614
    v_mov_b32 v34, 4284592614
    v_mov_b32 v35, 4284592614
    v_mov_b32 v86, 0
    v_mov_b32 v87, 0
    v_and_b32 v15, 31, v1
    v_lshlrev_b32 v15, 2, v15
    s_waitcnt lgkmcnt(0)
L_wo:
    s_lshl_b32 s82, s3, 12
    s_add_u32 s82, s82, s85
    s_waitcnt lgkmcnt(0)
    s_barrier
    s_mov_b32 s95, 0x200000
Lp_8:
    buffer_load_dword v243, v15, s[44:47], s84 offen sc1
    s_waitcnt vmcnt(0)
    v_cmp_ne_u32 vcc, s90, v243
    s_nop 0
    s_cmp_eq_u64 vcc, 0
    s_nop 1
    s_cbranch_scc1 Ld_9
    s_sub_u32 s95, s95, 1
    s_cmp_lg_u32 s95, 0
    s_cbranch_scc1 Lp_8
    s_branch L_abort
Ld_9:
    s_add_u32 m0, s63, 0
    s_nop 0
    buffer_load_dwordx4 v12, s[44:47], s82 offen offset:0 sc1 lds
    s_add_u32 m0, s63, 20224
    s_nop 0
    buffer_load_dwordx4 v12, s[44:47], s82 offen offset:256 sc1 lds
    s_add_u32 m0, s63, 40448
    s_nop 0
    buffer_load_dwordx4 v12, s[44:47], s82 offen offset:512 sc1 lds
    s_add_u32 m0, s63, 60672
    s_nop 0
    buffer_load_dwordx4 v12, s[44:47], s82 offen offset:768 sc1 lds
    s_add_u32 s82, s82, 16384
    s_add_u32 m0, s63, 4096
    s_nop 0
    buffer_load_dwordx4 v12, s[44:47], s82 offen offset:0 sc1 lds
    s_add_u32 m0, s63, 24320
    s_nop 0
    buffer_load_dwordx4 v12, s[44:47], s82 offen offset:256 sc1 lds
    s_add_u32 m0, s63, 44544
    s_nop 0
    buffer_load_dwordx4 v12, s[44:47], s82 offen offset:512 sc1 lds
    s_add_u32 m0, s63, 64768
    s_nop 0
    buffer_load_dwordx4 v12, s[44:47], s82 offen offset:768 sc1 lds
    s_cmp_lg_u32 s92, 0
    s_cbranch_scc1 Lu_10
    v_lshlrev_b32 v52, 16, v72
    v_and_b32 v53, 0xffff0000, v72
    v_lshlrev_b32 v54, 16, v73
    v_and_b32 v55, 0xffff0000, v73
    v_lshlrev_b32 v56, 16, v74
    v_and_b32 v57, 0xffff0000, v74
    v_lshlrev_b32 v58, 16, v75
    v_and_b32 v59, 0xffff0000, v75
    v_lshlrev_b32 v60, 16, v76
    v_and_b32 v61, 0xffff0000, v76
    v_lshlrev_b32 v62, 16, v77
    v_and_b32 v63, 0xffff0000, v77
    v_lshlrev_b32 v64, 16, v78
    v_and_b32 v65, 0xffff0000, v78
    v_lshlrev_b32 v66, 16, v79
    v_and_b32 v67, 0xffff0000, v79
    v_lshlrev_b32 v68, 16, v80
    v_and_b32 v69, 0xffff0000, v80
    v_lshlrev_b32 v70, 16, v81
    v_and_b32 v71, 0xffff0000, v81
Lu_10:
    s_add_u32 s85, s72, 81920
    s_add_u32 s84, s72, 174592
    s_add_u32 s66, s72, 163840
    s_add_u32 s67, s90, s92
    s_cmp_eq_u32 s92, 0
    s_cselect_b64 s[100:101], s[28:29], 0
    s_cselect_b64 s[96:97], s[16:17], 0
    s_waitcnt vmcnt(4)
    s_barrier
    ds_read_b128 v[168:171], v4 offset:0
    ds_read_b128 v[172:175], v5 offset:0
    ds_read_b128 v[176:179], v6 offset:0
    ds_read_b128 v[180:183], v7 offset:0
    s_add_u32 s82, s82, 16384
    s_add_u32 m0, s63, 8192
    s_nop 0
    buffer_load_dwordx4 v12, s[44:47], s82 offen offset:0 sc1 lds
    ds_read_b128 v[184:187], v4 offset:20480
    ds_read_b128 v[188:191], v5 offset:20480
    ds_read_b128 v[192:195], v6 offset:20480
    ds_read_b128 v[196:199], v7 offset:20480
    s_add_u32 m0, s63, 28416
    s_nop 0
    buffer_load_dwordx4 v12, s[44:47], s82 offen offset:256 sc1 lds
    ds_read_b128 v[200:203], v8 offset:0
    ds_read_b128 v[204:207], v9 offset:0
    ds_read_b128 v[208:211], v10 offset:0
    ds_read_b128 v[212:215], v11 offset:0
    s_add_u32 m0, s63, 48640
    s_nop 0
    buffer_load_dwordx4 v12, s[44:47], s82 offen offset:512 sc1 lds
    ds_read_b128 v[216:219], v8 offset:20480
    ds_read_b128 v[220:223], v9 offset:20480
    ds_read_b128 v[224:227], v10 offset:20480
    ds_read_b128 v[228:231], v11 offset:20480
    s_add_u32 m0, s63, 68864
    s_nop 0
    buffer_load_dwordx4 v12, s[44:47], s82 offen offset:768 sc1 lds
    s_waitcnt vmcnt(4)
    s_barrier
    s_waitcnt lgkmcnt(15)
    v_mfma_f32_16x16x32_bf16 v[100:103], a[192:195], v[168:171], 0
    ds_read_b128 v[168:171], v4 offset:4096
    s_add_u32 s82, s82, 16384
    s_waitcnt lgkmcnt(15)
    v_mfma_f32_16x16x32_bf16 v[100:103], a[196:199], v[172:175], v[100:103]
    ds_read_b128 v[172:175], v5 offset:4096
    s_add_u32 m0, s63, 12288
    s_waitcnt lgkmcnt(14)
    v_mfma_f32_16x16x32_bf16 v[100:103], a[200:203], v[176:179], v[100:103]
    ds_read_b128 v[176:179], v6 offset:4096
    buffer_load_dwordx4 v12, s[44:47], s82 offen offset:0 sc1 lds
    v_mfma_f32_16x16x32_bf16 v[100:103], a[204:207], v[180:183], v[100:103]
    ds_read_b128 v[180:183], v7 offset:4096
    s_add_u32 m0, s63, 32512
    s_waitcnt lgkmcnt(12)
    v_mfma_f32_16x16x32_bf16 v[100:103], a[208:211], v[184:187], v[100:103]
    ds_read_b128 v[184:187], v4 offset:24576
    buffer_load_dwordx4 v12, s[44:47], s82 offen offset:256 sc1 lds
    v_mfma_f32_16x16x32_bf16 v[100:103], a[212:215], v[188:191], v[100:103]
    ds_read_b128 v[188:191], v5 offset:24576
    s_add_u32 m0, s63, 52736
    v_mfma_f32_16x16x32_bf16 v[100:103], a[216:219], v[192:195], v[100:103]
    ds_read_b128 v[192:195], v6 offset:24576
    buffer_load_dwordx4 v12, s[44:47], s82 offen offset:512 sc1 lds
    v_mfma_f32_16x16x32_bf16 v[100:103], a[220:223], v[196:199], v[100:103]
    ds_read_b128 v[196:199], v7 offset:24576
    s_add_u32 m0, s63, 72960
    s_waitcnt lgkmcnt(8)
    v_mfma_f32_16x16x32_bf16 v[100:103], a[224:227], v[200:203], v[100:103]
    ds_read_b128 v[200:203], v8 offset:4096
    buffer_load_dwordx4 v12, s[44:47], s82 offen offset:768 sc1 lds
    v_mfma_f32_16x16x32_bf16 v[100:103], a[228:231], v[204:207], v[100:103]
    ds_read_b128 v[204:207], v9 offset:4096
    v_mfma_f32_16x16x32_bf16 v[100:103], a[232:235], v[208:211], v[100:103]
    ds_read_b128 v[208:211], v10 offset:4096
    v_mfma_f32_16x16x32_bf16 v[100:103], a[236:239], v[212:215], v[100:103]
    ds_read_b128 v[212:215], v11 offset:4096
    v_mfma_f32_16x16x32_bf16 v[100:103], a[240:243], v[216:219], v[100:103]
    ds_read_b128 v[216:219], v8 offset:24576
    v_mfma_f32_16x16x32_bf16 v[100:103], a[244:247], v[220:223], v[100:103]
    ds_read_b128 v[220:223], v9 offset:24576
    v_mfma_f32_16x16x32_bf16 v[100:103], a[248:251], v[224:227], v[100:103]
    ds_read_b128 v[224:227], v10 offset:24576
    v_mfma_f32_16x16x32_bf16 v[100:103], a[252:255], v[228:231], v[100:103]
    ds_read_b128 v[228:231], v11 offset:24576
    s_waitcnt vmcnt(4)
    s_barrier
    s_waitcnt lgkmcnt(11)
    v_mfma_f32_16x16x32_bf16 v[104:107], a[192:195], v[168:171], 0
    ds_read_b128 v[168:171], v4 offset:8192
    v_mfma_f32_16x16x32_bf16 v[104:107], a[196:199], v[172:175], v[104:107]
    ds_read_b128 v[172:175], v5 offset:8192
    v_mfma_f32_16x16x32_bf16 v[104:107], a[200:203], v[176:179], v[104:107]
    ds_read_b128 v[176:179], v6 offset:8192
    v_add_f32 v140, v52, v100
    v_mfma_f32_16x16x32_bf16 v[104:107], a[204:207], v[180:183], v[104:107]
    ds_read_b128 v[180:183], v7 offset:8192
    v_add_f32 v141, v53, v101
    v_mfma_f32_16x16x32_bf16 v[104:107], a[208:211], v[184:187], v[104:107]
    ds_read_b128 v[184:187], v4 offset:28672
    s_add_u32 s82, s82, 16384
    s_waitcnt lgkmcnt(12)
    v_mfma_f32_16x16x32_bf16 v[104:107], a[212:215], v[188:191], v[104:107]
    ds_read_b128 v[188:191], v5 offset:28672
    s_add_u32 m0, s63, 16384
    v_mfma_f32_16x16x32_bf16 v[104:107], a[216:219], v[192:195], v[104:107]
    ds_read_b128 v[192:195], v6 offset:28672
    buffer_load_dwordx4 v12, s[44:47], s82 offen offset:0 sc1 lds
    v_mfma_f32_16x16x32_bf16 v[104:107], a[220:223], v[196:199], v[104:107]
    ds_read_b128 v[196:199], v7 offset:28672
    v_add_f32 v142, v54, v102
    v_mfma_f32_16x16x32_bf16 v[104:107], a[224:227], v[200:203], v[104:107]
    ds_read_b128 v[200:203], v8 offset:8192
    v_add_f32 v143, v55, v103
    s_waitcnt lgkmcnt(10)
    v_mfma_f32_16x16x32_bf16 v[104:107], a[228:231], v[204:207], v[104:107]
    ds_read_b128 v[204:207], v9 offset:8192
    v_cvt_pk_bf16_f32 v72, v140, v141
    v_mfma_f32_16x16x32_bf16 v[104:107], a[232:235], v[208:211], v[104:107]
    ds_read_b128 v[208:211], v10 offset:8192
    v_cvt_pk_bf16_f32 v73, v142, v143
    v_mfma_f32_16x16x32_bf16 v[104:107], a[236:239], v[212:215], v[104:107]
    ds_read_b128 v[212:215], v11 offset:8192
    s_add_u32 m0, s63, 36608
    v_mfma_f32_16x16x32_bf16 v[104:107], a[240:243], v[216:219], v[104:107]
    ds_read_b128 v[216:219], v8 offset:28672
    buffer_load_dwordx4 v12, s[44:47], s82 offen offset:256 sc1 lds
    v_mfma_f32_16x16x32_bf16 v[104:107], a[244:247], v[220:223], v[104:107]
    ds_read_b128 v[220:223], v9 offset:28672
    v_mul_f32 v120, v140, v140
    v_mfma_f32_16x16x32_bf16 v[104:107], a[248:251], v[224:227], v[104:107]
    ds_read_b128 v[224:227], v10 offset:28672
    v_mul_f32 v121, v141, v141
    s_waitcnt lgkmcnt(9)
    v_mfma_f32_16x16x32_bf16 v[104:107], a[252:255], v[228:231], v[104:107]
    ds_read_b128 v[228:231], v11 offset:28672
    v_mul_f32 v122, v142, v142
    v_mul_f32 v123, v143, v143
    s_add_u32 m0, s63, 56832
    s_nop 0
    buffer_load_dwordx4 v12, s[44:47], s82 offen offset:512 sc1 lds
    s_add_u32 s53, s85, 0
    s_mov_b64 exec, s[100:101]
    buffer_store_dwordx2 v[72:73], v13, s[44:47], s53 offen
    s_mov_b64 exec, s[96:97]
    buffer_store_dwordx2 v[72:73], v13, s[44:47], s53 offen  sc1
    s_mov_b64 exec, -1
    v_mfma_f32_16x16x16_bf16 v[128:131], v[48:49], v[72:73], 0
    v_cvt_pk_bf16_f32 v120, v120, v121
    s_add_u32 m0, s63, 77056
    s_nop 0
    buffer_load_dwordx4 v12, s[44:47], s82 offen offset:768 sc1 lds
    v_cvt_pk_bf16_f32 v121, v122, v123
    s_nop 1
    v_mfma_f32_16x16x16_bf16 v[128:131], v[50:51], v[120:121], v[128:131]
    s_waitcnt vmcnt(6)
    s_barrier
    v_mfma_f32_16x16x32_bf16 v[108:111], a[192:195], v[168:171], 0
    ds_read_b128 v[168:171], v4 offset:12288
    v_mfma_f32_16x16x32_bf16 v[108:111], a[196:199], v[172:175], v[108:111]
    ds_read_b128 v[172:175], v5 offset:12288
    v_mfma_f32_16x16x32_bf16 v[108:111], a[200:203], v[176:179], v[108:111]
    ds_read_b128 v[176:179], v6 offset:12288
    v_add_f32 v144, v56, v104
    v_mfma_f32_16x16x32_bf16 v[108:111], a[204:207], v[180:183], v[108:111]
    ds_read_b128 v[180:183], v7 offset:12288
    v_add_f32 v145, v57, v105
    v_mfma_f32_16x16x32_bf16 v[108:111], a[208:211], v[184:187], v[108:111]
    ds_read_b128 v[184:187], v4 offset:32768
    v_add_f32 v146, v58, v106
    v_mfma_f32_16x16x32_bf16 v[108:111], a[212:215], v[188:191], v[108:111]
    ds_read_b128 v[188:191], v5 offset:32768
    v_add_f32 v147, v59, v107
    s_waitcnt lgkmcnt(6)
    v_mfma_f32_16x16x32_bf16 v[108:111], a[216:219], v[192:195], v[108:111]
    ds_read_b128 v[192:195], v6 offset:32768
    v_cvt_pk_bf16_f32 v74, v144, v145
    v_mfma_f32_16x16x32_bf16 v[108:111], a[220:223], v[196:199], v[108:111]
    ds_read_b128 v[196:199], v7 offset:32768
    v_cvt_pk_bf16_f32 v75, v146, v147
    v_mfma_f32_16x16x32_bf16 v[108:111], a[224:227], v[200:203], v[108:111]
    ds_read_b128 v[200:203], v8 offset:12288
    ds_write_b128 v84, v[128:131] offset:0
    v_mfma_f32_16x16x32_bf16 v[108:111], a[228:231], v[204:207], v[108:111]
    ds_read_b128 v[204:207], v9 offset:12288
    v_mul_f32 v124, v144, v144
    v_mfma_f32_16x16x32_bf16 v[108:111], a[232:235], v[208:211], v[108:111]
    ds_read_b128 v[208:211], v10 offset:12288
    v_mul_f32 v125, v145, v145
    v_mfma_f32_16x16x32_bf16 v[108:111], a[236:239], v[212:215], v[108:111]
    ds_read_b128 v[212:215], v11 offset:12288
    v_mul_f32 v126, v146, v146
    v_mfma_f32_16x16x32_bf16 v[108:111], a[240:243], v[216:219], v[108:111]
    ds_read_b128 v[216:219], v8 offset:32768
    v_mul_f32 v127, v147, v147
    v_mfma_f32_16x16x32_bf16 v[108:111], a[244:247], v[220:223], v[108:111]
    ds_read_b128 v[220:223], v9 offset:32768
    s_add_u32 s53, s85, 16384
    v_mfma_f32_16x16x32_bf16 v[108:111], a[248:251], v[224:227], v[108:111]
    ds_read_b128 v[224:227], v10 offset:32768
    s_mov_b64 exec, s[100:101]
    buffer_store_dwordx2 v[74:75], v13, s[44:47], s53 offen
    s_mov_b64 exec, s[96:97]
    buffer_store_dwordx2 v[74:75], v13, s[44:47], s53 offen  sc1
    s_mov_b64 exec, -1
    v_mfma_f32_16x16x16_bf16 v[132:135], v[48:49], v[74:75], 0
    v_cvt_pk_bf16_f32 v124, v124, v125
    v_cvt_pk_bf16_f32 v125, v126, v127
    v_mfma_f32_16x16x32_bf16 v[108:111], a[252:255], v[228:231], v[108:111]
    ds_read_b128 v[228:231], v11 offset:32768
    v_mfma_f32_16x16x16_bf16 v[132:135], v[50:51], v[124:125], v[132:135]
    s_waitcnt vmcnt(2)
    s_barrier
    s_waitcnt lgkmcnt(6)
    v_mfma_f32_16x16x32_bf16 v[112:115], a[192:195], v[168:171], 0
    ds_read_b128 v[168:171], v4 offset:16384
    v_mfma_f32_16x16x32_bf16 v[112:115], a[196:199], v[172:175], v[112:115]
    ds_read_b128 v[172:175], v5 offset:16384
    v_mfma_f32_16x16x32_bf16 v[112:115], a[200:203], v[176:179], v[112:115]
    ds_read_b128 v[176:179], v6 offset:16384
    v_add_f32 v148, v60, v108
    v_mfma_f32_16x16x32_bf16 v[112:115], a[204:207], v[180:183], v[112:115]
    ds_read_b128 v[180:183], v7 offset:16384
    v_add_f32 v149, v61, v109
    v_mfma_f32_16x16x32_bf16 v[112:115], a[208:211], v[184:187], v[112:115]
    ds_read_b128 v[184:187], v4 offset:36864
    v_add_f32 v150, v62, v110
    v_mfma_f32_16x16x32_bf16 v[112:115], a[212:215], v[188:191], v[112:115]
    ds_read_b128 v[188:191], v5 offset:36864
    v_add_f32 v151, v63, v111
    v_mfma_f32_16x16x32_bf16 v[112:115], a[216:219], v[192:195], v[112:115]
    ds_read_b128 v[192:195], v6 offset:36864
    v_cvt_pk_bf16_f32 v76, v148, v149
    v_mfma_f32_16x16x32_bf16 v[112:115], a[220:223], v[196:199], v[112:115]
    ds_read_b128 v[196:199], v7 offset:36864
    v_cvt_pk_bf16_f32 v77, v150, v151
    v_mfma_f32_16x16x32_bf16 v[112:115], a[224:227], v[200:203], v[112:115]
    ds_read_b128 v[200:203], v8 offset:16384
    ds_write_b128 v84, v[132:135] offset:1280
    v_mfma_f32_16x16x32_bf16 v[112:115], a[228:231], v[204:207], v[112:115]
    ds_read_b128 v[204:207], v9 offset:16384
    v_mul_f32 v120, v148, v148
    s_waitcnt lgkmcnt(11)
    v_mfma_f32_16x16x32_bf16 v[112:115], a[232:235], v[208:211], v[112:115]
    ds_read_b128 v[208:211], v10 offset:16384
    v_mul_f32 v121, v149, v149
    v_mfma_f32_16x16x32_bf16 v[112:115], a[236:239], v[212:215], v[112:115]
    ds_read_b128 v[212:215], v11 offset:16384
    v_mul_f32 v122, v150, v150
    v_mfma_f32_16x16x32_bf16 v[112:115], a[240:243], v[216:219], v[112:115]
    ds_read_b128 v[216:219], v8 offset:36864
    v_mul_f32 v123, v151, v151
    v_mfma_f32_16x16x32_bf16 v[112:115], a[244:247], v[220:223], v[112:115]
    ds_read_b128 v[220:223], v9 offset:36864
    s_add_u32 s53, s85, 32768
    v_mfma_f32_16x16x32_bf16 v[112:115], a[248:251], v[224:227], v[112:115]
    ds_read_b128 v[224:227], v10 offset:36864
    s_mov_b64 exec, s[100:101]
    buffer_store_dwordx2 v[76:77], v13, s[44:47], s53 offen
    s_mov_b64 exec, s[96:97]
    buffer_store_dwordx2 v[76:77], v13, s[44:47], s53 offen  sc1
    s_mov_b64 exec, -1
    v_mfma_f32_16x16x16_bf16 v[128:131], v[48:49], v[76:77], 0
    v_cvt_pk_bf16_f32 v120, v120, v121
    v_cvt_pk_bf16_f32 v121, v122, v123
    v_mfma_f32_16x16x32_bf16 v[112:115], a[252:255], v[228:231], v[112:115]
    ds_read_b128 v[228:231], v11 offset:36864
    v_mfma_f32_16x16x16_bf16 v[128:131], v[50:51], v[120:121], v[128:131]
    s_waitcnt lgkmcnt(7)
    v_mfma_f32_16x16x32_bf16 v[116:119], a[192:195], v[168:171], 0
    v_mfma_f32_16x16x32_bf16 v[116:119], a[196:199], v[172:175], v[116:119]
    v_mfma_f32_16x16x32_bf16 v[116:119], a[200:203], v[176:179], v[116:119]
    s_nop 1
    v_add_f32 v152, v64, v112
    v_min_u32 v160, 79, v0
    v_mfma_f32_16x16x32_bf16 v[116:119], a[204:207], v[180:183], v[116:119]
    v_add_f32 v153, v65, v113
    v_add_f32 v154, v66, v114
    v_mfma_f32_16x16x32_bf16 v[116:119], a[208:211], v[184:187], v[116:119]
    v_mul_u32_u24 v161, 80, v160
    v_add_f32 v155, v67, v115
    v_mfma_f32_16x16x32_bf16 v[116:119], a[212:215], v[188:191], v[116:119]
    v_cvt_pk_bf16_f32 v78, v152, v153
    v_add_u32 v161, 98304, v161
    v_mfma_f32_16x16x32_bf16 v[116:119], a[216:219], v[192:195], v[116:119]
    v_cvt_pk_bf16_f32 v79, v154, v155
    ds_write_b128 v84, v[128:131] offset:2560
    v_mfma_f32_16x16x32_bf16 v[116:119], a[220:223], v[196:199], v[116:119]
    v_lshlrev_b32 v160, 4, v160
    v_mul_f32 v124, v152, v152
    v_mfma_f32_16x16x32_bf16 v[116:119], a[224:227], v[200:203], v[116:119]
    v_mul_f32 v125, v153, v153
    s_mul_i32 s54, s7, 1280
    s_waitcnt lgkmcnt(2)
    v_mfma_f32_16x16x32_bf16 v[116:119], a[228:231], v[204:207], v[116:119]
    v_mul_f32 v126, v154, v154
    v_mul_f32 v127, v155, v155
    v_mfma_f32_16x16x32_bf16 v[116:119], a[232:235], v[208:211], v[116:119]
    s_add_u32 s54, s54, s66
    s_add_u32 s53, s85, 49152
    v_mfma_f32_16x16x32_bf16 v[116:119], a[236:239], v[212:215], v[116:119]
    s_mov_b64 exec, s[100:101]
    buffer_store_dwordx2 v[78:79], v13, s[44:47], s53 offen
    s_mov_b64 exec, s[96:97]
    buffer_store_dwordx2 v[78:79], v13, s[44:47], s53 offen  sc1
    s_mov_b64 exec, -1
    v_mov_b32 v240, s90
    v_mfma_f32_16x16x16_bf16 v[132:135], v[48:49], v[78:79], 0
    v_cvt_pk_bf16_f32 v124, v124, v125
    v_mov_b32 v241, s65
    v_mfma_f32_16x16x32_bf16 v[116:119], a[240:243], v[216:219], v[116:119]
    v_cvt_pk_bf16_f32 v125, v126, v127
    v_mfma_f32_16x16x32_bf16 v[116:119], a[244:247], v[220:223], v[116:119]
    v_mfma_f32_16x16x32_bf16 v[116:119], a[248:251], v[224:227], v[116:119]
    v_mfma_f32_16x16x16_bf16 v[132:135], v[50:51], v[124:125], v[132:135]
    v_cmp_gt_u32 s[98:99], s13, v0
    s_waitcnt lgkmcnt(0)
    v_mfma_f32_16x16x32_bf16 v[116:119], a[252:255], v[228:231], v[116:119]
    s_nop 4
    ds_write_b128 v84, v[132:135] offset:3840
    s_nop 1
    v_add_f32 v156, v68, v116
    v_add_f32 v157, v69, v117
    v_add_f32 v158, v70, v118
    v_add_f32 v159, v71, v119
    v_cvt_pk_bf16_f32 v80, v156, v157
    v_cvt_pk_bf16_f32 v81, v158, v159
    s_add_u32 s53, s85, 65536
    s_mov_b64 exec, s[100:101]
    buffer_store_dwordx2 v[80:81], v13, s[44:47], s53 offen
    s_mov_b64 exec, s[96:97]
    buffer_store_dwordx2 v[80:81], v13, s[44:47], s53 offen  sc1
    s_mov_b64 exec, -1
    v_mul_f32 v120, v156, v156
    v_mul_f32 v121, v157, v157
    v_mul_f32 v122, v158, v158
    v_mul_f32 v123, v159, v159
    v_mfma_f32_16x16x16_bf16 v[128:131], v[48:49], v[80:81], 0
    v_cvt_pk_bf16_f32 v120, v120, v121
    v_cvt_pk_bf16_f32 v121, v122, v123
    s_nop 1
    v_mfma_f32_16x16x16_bf16 v[128:131], v[50:51], v[120:121], v[128:131]
    s_nop 7
    ds_write_b128 v84, v[128:131] offset:5120
    s_waitcnt lgkmcnt(0)
    s_barrier
    ds_read_b128 v[168:171], v161 offset:0
    ds_read_b128 v[172:175], v161 offset:16
    ds_read_b128 v[176:179], v161 offset:32
    ds_read_b128 v[180:183], v161 offset:48
    s_waitcnt lgkmcnt(2)
    v_pk_add_f32 v[168:169], v[168:169], v[172:173]
    v_add_f32 v170, v170, v174
    s_waitcnt lgkmcnt(0)
    v_pk_add_f32 v[176:177], v[176:177], v[180:181]
    v_add_f32 v178, v178, v182
    v_mov_b32 v171, s67
    v_pk_add_f32 v[168:169], v[168:169], v[176:177]
    v_add_f32 v170, v170, v178
    s_mov_b64 exec, s[98:99]
    s_cmp_eq_u32 s91, 1
    s_cbranch_scc0 Ls_11
    buffer_store_dwordx4 v[168:171], v160, s[44:47], s54 offen
    s_nop 0
    s_branch Le_12
Ls_11:
    buffer_store_dwordx4 v[168:171], v160, s[44:47], s54 offen sc1
Le_12:
    s_mov_b64 exec, -1
    s_cmp_lg_u32 s92, 0
    s_cbranch_scc1 Ly_13
    s_waitcnt vmcnt(1)
    s_mov_b64 exec, s[28:29]
    buffer_store_dword v240, v241, s[44:47], s84 offen
    s_mov_b64 exec, s[16:17]
    buffer_store_dword v240, v241, s[44:47], s84 offen sc1
    s_mov_b64 exec, -1
Ly_13:
    v_lshrrev_b32 v161, 1, v0
    v_min_u32 v161, 79, v161
    v_and_b32 v160, 1, v0
    v_mul_u32_u24 v160, 5120, v160
    v_lshl_add_u32 v160, v161, 4, v160
    s_lshr_b32 s52, s69, 10
    v_lshlrev_b32 v162, 1, v161
    v_add_u32 v162, s52, v162
    s_cmp_lg_u32 s68, 0
    s_cselect_b32 s53, 7, 0
    s_movk_i32 s54, 2048
    v_cmp_le_u32 vcc, s53, v161
    v_cmp_gt_u32 s[96:97], s54, v162
    s_nop 0
    s_and_b64 s[98:99], vcc, s[96:97]
    v_subrev_u32 v163, s8, v162
    v_and_b32 v163, 0xfffffff1, v163
    v_cmp_ne_u32 vcc, 0, v163
    s_nop 0
    s_and_b64 s[98:99], vcc, s[98:99]
    v_subrev_u32 v163, s9, v162
    v_and_b32 v163, 0xfffffff1, v163
    v_cmp_ne_u32 vcc, 0, v163
    s_nop 0
    s_and_b64 s[98:99], vcc, s[98:99]
    v_lshlrev_b32 v161, 2, v161
    v_add_u32 v161, 159744, v161
    v_lshlrev_b32 v163, 2, v1
    v_add_u32 v163, 161280, v163
    v_mov_b32 v191, s90
    v_mov_b32 v193, s90
    v_mov_b32 v195, s90
    v_mov_b32 v197, s90
    v_mov_b32 v199, s90
    v_lshlrev_b32 v185, 1, v14
    s_lshl_b32 s52, s92, 12
    s_add_u32 s52, s52, s72
    s_add_u32 s14, s52, 175104
    s_lshl_b32 s52, s92, 11
    s_lshl_b32 s53, s6, 5
    s_add_u32 s52, s52, s53
    s_add_u32 s15, s52, 4096
    s_cmp_eq_u32 s7, 0
    s_cselect_b64 s[100:101], -1, 0
    s_mul_i32 s54, s7, 10
    v_mul_u32_u24 v82, 20480, v2
    v_lshlrev_b32 v16, 4, v1
    s_add_u32 s75, s72, 184320
    s_add_u32 s55, s3, 0
    s_add_u32 s55, s55, s54
    s_and_b32 s74, s55, 15
    v_xor_b32 v85, s74, v3
    s_lshl_b32 s74, s55, 8
    v_lshlrev_b32 v85, 4, v85
    v_add3_u32 v85, v85, v82, s74
    s_lshl_b32 s55, s55, 10
    s_add_u32 s19, s55, s75
    s_add_u32 s55, s3, 4
    s_add_u32 s55, s55, s54
    s_and_b32 s74, s55, 15
    v_xor_b32 v98, s74, v3
    s_lshl_b32 s74, s55, 8
    v_lshlrev_b32 v98, 4, v98
    v_add3_u32 v98, v98, v82, s74
    s_lshl_b32 s55, s55, 10
    s_add_u32 s20, s55, s75
    s_and_b32 s55, s3, 1
    s_add_u32 s55, s55, 8
    s_add_u32 s55, s55, s54
    s_and_b32 s74, s55, 15
    v_xor_b32 v99, s74, v3
    s_lshl_b32 s74, s55, 8
    v_lshlrev_b32 v99, 4, v99
    v_add3_u32 v99, v99, v82, s74
    s_lshl_b32 s55, s55, 10
    s_add_u32 s21, s55, s75
    v_min_u32 v82, 39, v1
    v_and_b32 v19, 3, v82
    v_mul_u32_u24 v19, 384, v19
    v_and_b32 v83, 0x3c, v82
    s_mul_i32 s55, s7, 40
    s_add_u32 s74, s55, 159744
    v_add3_u32 v19, v19, v83, s74
    v_lshlrev_b32 v82, 2, v82
    s_lshl_b32 s55, s55, 2
    s_add_u32 s55, s55, s72
    s_add_u32 s22, s55, 266240
    s_lshl_b32 s82, s3, 12
    s_add_u32 s82, s82, s85
    s_cmp_eq_u32 s92, 0
    s_cselect_b32 s53, 0, 256
    s_sub_u32 s53, s84, s53
    s_add_u32 s52, s66, 3840
    s_mov_b32 s95, 0x200000
Lp_14:
    buffer_load_dword v243, v15, s[44:47], s53 offen sc1
    buffer_load_dwordx4 v[164:167], v160, s[44:47], s66 offen offset:0 sc1
    buffer_load_dwordx4 v[168:171], v160, s[44:47], s66 offen offset:1280 sc1
    buffer_load_dwordx4 v[172:175], v160, s[44:47], s66 offen offset:2560 sc1
    buffer_load_dwordx4 v[176:179], v160, s[44:47], s52 offen sc1
    s_waitcnt vmcnt(0)
    v_cmp_ne_u32 vcc, s67, v167
    v_cmp_ne_u32 s[96:97], s67, v171
    s_nop 0
    s_or_b64 vcc, vcc, s[96:97]
    v_cmp_ne_u32 s[96:97], s67, v175
    s_nop 0
    s_or_b64 vcc, vcc, s[96:97]
    v_cmp_ne_u32 s[96:97], s67, v179
    s_nop 0
    s_or_b64 vcc, vcc, s[96:97]
    v_cmp_ne_u32 s[96:97], s90, v243
    s_nop 0
    s_or_b64 vcc, vcc, s[96:97]
    s_cmp_eq_u64 vcc, 0
    s_nop 0
    s_cbranch_scc1 Ld_15
    s_sub_u32 s95, s95, 1
    s_cmp_lg_u32 s95, 0
    s_cbranch_scc1 Lp_14
    s_branch L_abort
Ld_15:
    s_cmp_lg_u32 s92, 0
    s_cbranch_scc1 L_final
    s_add_u32 m0, s63, 0
    s_nop 0
    buffer_load_dwordx4 v12, s[44:47], s82 offen offset:0 sc1 lds
    s_add_u32 m0, s63, 20224
    s_nop 0
    buffer_load_dwordx4 v12, s[44:47], s82 offen offset:256 sc1 lds
    s_add_u32 m0, s63, 40448
    s_nop 0
    buffer_load_dwordx4 v12, s[44:47], s82 offen offset:512 sc1 lds
    s_add_u32 m0, s63, 60672
    s_nop 0
    buffer_load_dwordx4 v12, s[44:47], s82 offen offset:768 sc1 lds
    s_add_u32 s82, s82, 16384
    s_add_u32 m0, s63, 4096
    s_nop 0
    buffer_load_dwordx4 v12, s[44:47], s82 offen offset:0 sc1 lds
    s_add_u32 m0, s63, 24320
    s_nop 0
    buffer_load_dwordx4 v12, s[44:47], s82 offen offset:256 sc1 lds
    s_add_u32 m0, s63, 44544
    s_nop 0
    buffer_load_dwordx4 v12, s[44:47], s82 offen offset:512 sc1 lds
    s_add_u32 m0, s63, 64768
    s_nop 0
    buffer_load_dwordx4 v12, s[44:47], s82 offen offset:768 sc1 lds
    s_add_u32 s11, s72, 174848
    s_mov_b32 s85, s72
    s_add_u32 s84, s72, 174336
    v_add_f32 v166, v166, v170
    v_add_f32 v164, v164, v168
    v_add_f32 v165, v165, v169
    v_add_f32 v174, v174, v178
    v_add_f32 v172, v172, v176
    v_add_f32 v173, v173, v177
    v_add_f32 v166, v166, v174
    v_add_f32 v164, v164, v172
    v_add_f32 v165, v165, v173
    v_add_f32_dpp v166, v166, v166 quad_perm:[1,0,3,2] row_mask:0xf bank_mask:0xf
    v_add_f32_dpp v164, v164, v164 quad_perm:[1,0,3,2] row_mask:0xf bank_mask:0xf
    v_add_f32_dpp v165, v165, v165 quad_perm:[1,0,3,2] row_mask:0xf bank_mask:0xf
    v_mul_f32 v180, 0x3b000000, v164
    v_mul_f32 v181, 0x3b000000, v166
    v_fma_f32 v181, -v180, v180, v181
    v_max_f32 v181, 0, v181
    v_cvt_pk_bf16_f32 v190, v181, v181
    v_lshlrev_b32 v190, 16, v190
    v_add_f32 v190, 0x3727c5ac, v190
    v_cvt_pk_bf16_f32 v190, v190, v190
    v_lshlrev_b32 v190, 16, v190
    v_sqrt_f32 v190, v190
    v_cvt_pk_bf16_f32 v189, v180, v180
    v_cvt_pk_bf16_f32 v190, v190, v190
    v_lshlrev_b32 v190, 16, v190
    v_rcp_f32 v190, v190
    v_lshlrev_b32 v189, 16, v189
    v_fma_f32 v184, -v189, s93, v165
    v_add_f32 v182, 1.0, v190
    v_mul_f32 v184, v184, v190
    v_mul_f32 v183, -v189, v190
    v_ashrrev_i32 v188, 31, v184
    ds_write_b32 v161, v182 offset:768
    v_or_b32 v188, 0x80000000, v188
    ds_write_b32 v161, v183 offset:1152
    v_xor_b32 v188, v188, v184
    v_and_or_b32 v188, v188, s18, v162
    v_cndmask_b32 v188, 0, v188, s[98:99]
    ds_write_b32 v161, v188 offset:1536
    s_waitcnt vmcnt(4)
    s_waitcnt lgkmcnt(0)
    s_barrier
    ds_read_b32 v164, v163
    ds_read_b32 v165, v252 offset:1792
    ds_read_b128 v[216:219], v4 offset:0
    ds_read_b128 v[220:223], v5 offset:0
    ds_read_b128 v[224:227], v6 offset:0
    ds_read_b128 v[228:231], v7 offset:0
    ds_read_b128 v[232:235], v4 offset:20480
    ds_read_b128 v[236:239], v5 offset:20480
    ds_read_b128 v[240:243], v6 offset:20480
    ds_read_b128 v[244:247], v7 offset:20480
    s_waitcnt lgkmcnt(8)
    v_max_u32 v186, v164, v165
    v_fma_f32 v166, v180, v182, v183
    s_nop 0
    v_max_u32_dpp v186, v186, v186 quad_perm:[1,0,3,2] row_mask:0xf bank_mask:0xf
    v_mul_f32 v167, v182, v182
    s_nop 0
    v_max_u32_dpp v186, v186, v186 quad_perm:[2,3,0,1] row_mask:0xf bank_mask:0xf
    v_mul_f32 v167, v167, v181
    s_nop 0
    v_max_u32_dpp v186, v186, v186 row_half_mirror row_mask:0xf bank_mask:0xf
    v_cvt_pk_bf16_f32 v169, v167, v167
    s_nop 0
    v_max_u32_dpp v186, v186, v186 row_mirror row_mask:0xf bank_mask:0xf
    v_lshlrev_b32 v169, 16, v169
    s_nop 0
    v_max_u32_dpp v186, v186, v186 row_bcast:15 row_mask:0xa bank_mask:0xf
    v_add_f32 v169, 0x3727c5ac, v169
    s_nop 0
    v_max_u32_dpp v186, v186, v186 row_bcast:31 row_mask:0xc bank_mask:0xf
    v_cvt_pk_bf16_f32 v169, v169, v169
    v_readlane_b32 s70, v186, 63
    v_lshlrev_b32 v169, 16, v169
    s_nop 0
    v_cmp_ne_u32 vcc, s70, v164
    v_sqrt_f32 v169, v169
    s_nop 0
    v_cndmask_b32 v186, 0, v164, vcc
    v_cvt_pk_bf16_f32 v168, v166, v166
    v_cmp_ne_u32 vcc, s70, v165
    v_cvt_pk_bf16_f32 v169, v169, v169
    s_nop 0
    v_cndmask_b32 v187, 0, v165, vcc
    v_lshlrev_b32 v169, 16, v169
    v_max_u32 v186, v186, v187
    v_rcp_f32 v169, v169
    s_nop 0
    v_max_u32_dpp v186, v186, v186 quad_perm:[1,0,3,2] row_mask:0xf bank_mask:0xf
    v_lshlrev_b32 v168, 16, v168
    s_nop 0
    v_max_u32_dpp v186, v186, v186 quad_perm:[2,3,0,1] row_mask:0xf bank_mask:0xf
    v_rcp_f32 v167, v182
    s_nop 0
    v_max_u32_dpp v186, v186, v186 row_half_mirror row_mask:0xf bank_mask:0xf
    v_sub_f32 v168, v183, v168
    s_nop 0
    v_max_u32_dpp v186, v186, v186 row_mirror row_mask:0xf bank_mask:0xf
    v_mul_f32 v169, v169, v182
    s_nop 0
    v_max_u32_dpp v186, v186, v186 row_bcast:15 row_mask:0xa bank_mask:0xf
    v_mul_f32 v168, v168, v167
    s_nop 0
    v_max_u32_dpp v186, v186, v186 row_bcast:31 row_mask:0xc bank_mask:0xf
    ds_write2_b32 v161, v169, v168 offset0:0 offset1:96
    v_readlane_b32 s71, v186, 63
    ds_read_b32 v170, v252 offset:768
    s_nop 0
    v_cmp_eq_u32 vcc, s71, v188
    ds_read_b32 v171, v252 offset:1152
    v_cmp_eq_u32 s[96:97], s70, v188
    ds_read_b32 v172, v252 offset:832
    v_cndmask_b32 v186, 0, 16, vcc
    ds_read_b32 v173, v252 offset:1216
    s_or_b64 vcc, vcc, s[96:97]
    ds_read_b32 v174, v252 offset:896
    s_and_b64 exec, vcc, s[100:101]
    buffer_store_dwordx4 v[188:191], v186, s[44:47], s15 offen sc1
    s_mov_b64 exec, -1
    ds_read_b32 v175, v252 offset:1280
    s_bfe_u32 s74, s70, 0xa0001
    ds_read_b32 v176, v252 offset:960
    s_sub_u32 s74, s74, s31
    ds_read_b32 v177, v252 offset:1344
    s_lshr_b32 s54, s74, 4
    ds_read_b32 v178, v252 offset:1024
    s_lshl_b32 s54, s54, 1
    ds_read_b32 v179, v252 offset:1408
    s_and_b32 s53, s74, 15
    s_set_gpr_idx_on s54, gpr_idx(SRC0)
    v_mov_b32 v192, v72
    v_mov_b32 v194, v73
    s_set_gpr_idx_off
    v_cmp_eq_u32 vcc, s53, v3
    s_nop 0
    s_mov_b64 exec, vcc
    buffer_store_dwordx4 v[192:195], v185, s[44:47], s14 offen offset:0 sc1
    s_mov_b64 exec, -1
    s_bfe_u32 s75, s71, 0xa0001
    s_sub_u32 s75, s75, s31
    s_lshr_b32 s54, s75, 4
    s_lshl_b32 s54, s54, 1
    s_and_b32 s53, s75, 15
    s_set_gpr_idx_on s54, gpr_idx(SRC0)
    v_mov_b32 v196, v72
    v_mov_b32 v198, v73
    s_set_gpr_idx_off
    v_cmp_eq_u32 vcc, s53, v3
    s_nop 0
    s_mov_b64 exec, vcc
    buffer_store_dwordx4 v[196:199], v185, s[44:47], s14 offen offset:2048 sc1
    s_mov_b64 exec, -1
    s_waitcnt lgkmcnt(3)
    v_mfma_f32_16x16x32_bf16 v[100:103], a[0:3], v[216:219], 0
    s_add_u32 s82, s82, 16384
    s_add_u32 m0, s63, 8192
    v_mfma_f32_16x16x32_bf16 v[104:107], a[4:7], v[216:219], 0
    buffer_load_dwordx4 v12, s[44:47], s82 offen offset:0 sc1 lds
    v_mfma_f32_16x16x32_bf16 v[108:111], v[216:219], a[8:11], 0
    ds_read_b128 v[216:219], v8 offset:0
    v_fma_f32 v52, v140, v170, v171
    v_mfma_f32_16x16x32_bf16 v[100:103], a[12:15], v[220:223], v[100:103]
    v_fma_f32 v53, v141, v170, v171
    s_add_u32 m0, s63, 28416
    v_mfma_f32_16x16x32_bf16 v[104:107], a[16:19], v[220:223], v[104:107]
    buffer_load_dwordx4 v12, s[44:47], s82 offen offset:256 sc1 lds
    v_mfma_f32_16x16x32_bf16 v[108:111], v[220:223], a[20:23], v[108:111]
    ds_read_b128 v[220:223], v9 offset:0
    v_fma_f32 v54, v142, v170, v171
    v_mfma_f32_16x16x32_bf16 v[100:103], a[24:27], v[224:227], v[100:103]
    s_add_u32 m0, s63, 48640
    v_mfma_f32_16x16x32_bf16 v[104:107], a[28:31], v[224:227], v[104:107]
    buffer_load_dwordx4 v12, s[44:47], s82 offen offset:512 sc1 lds
    v_mfma_f32_16x16x32_bf16 v[108:111], v[224:227], a[32:35], v[108:111]
    ds_read_b128 v[224:227], v10 offset:0
    v_fma_f32 v55, v143, v170, v171
    v_mfma_f32_16x16x32_bf16 v[100:103], a[36:39], v[228:231], v[100:103]
    v_fma_f32 v56, v144, v172, v173
    s_add_u32 m0, s63, 68864
    v_mfma_f32_16x16x32_bf16 v[104:107], a[40:43], v[228:231], v[104:107]
    buffer_load_dwordx4 v12, s[44:47], s82 offen offset:768 sc1 lds
    v_mfma_f32_16x16x32_bf16 v[108:111], v[228:231], a[44:47], v[108:111]
    ds_read_b128 v[228:231], v11 offset:0
    v_fma_f32 v57, v145, v172, v173
    v_mfma_f32_16x16x32_bf16 v[100:103], a[48:51], v[232:235], v[100:103]
    v_fma_f32 v58, v146, v172, v173
    s_add_u32 s82, s82, 16384
    v_mfma_f32_16x16x32_bf16 v[104:107], a[52:55], v[232:235], v[104:107]
    s_add_u32 m0, s63, 12288
    v_mfma_f32_16x16x32_bf16 v[108:111], v[232:235], a[56:59], v[108:111]
    ds_read_b128 v[232:235], v8 offset:20480
    v_mfma_f32_16x16x32_bf16 v[100:103], a[60:63], v[236:239], v[100:103]
    buffer_load_dwordx4 v12, s[44:47], s82 offen offset:0 sc1 lds
    v_mfma_f32_16x16x32_bf16 v[104:107], a[64:67], v[236:239], v[104:107]
    v_fma_f32 v59, v147, v172, v173
    s_add_u32 m0, s63, 32512
    v_mfma_f32_16x16x32_bf16 v[108:111], v[236:239], a[68:71], v[108:111]
    ds_read_b128 v[236:239], v9 offset:20480
    v_mfma_f32_16x16x32_bf16 v[100:103], a[72:75], v[240:243], v[100:103]
    buffer_load_dwordx4 v12, s[44:47], s82 offen offset:256 sc1 lds
    v_mfma_f32_16x16x32_bf16 v[104:107], a[76:79], v[240:243], v[104:107]
    v_fma_f32 v60, v148, v174, v175
    v_fma_f32 v61, v149, v174, v175
    v_mfma_f32_16x16x32_bf16 v[108:111], v[240:243], a[80:83], v[108:111]
    ds_read_b128 v[240:243], v10 offset:20480
    s_add_u32 m0, s63, 52736
    v_mfma_f32_16x16x32_bf16 v[100:103], a[84:87], v[244:247], v[100:103]
    buffer_load_dwordx4 v12, s[44:47], s82 offen offset:512 sc1 lds
    v_mfma_f32_16x16x32_bf16 v[104:107], a[88:91], v[244:247], v[104:107]
    v_fma_f32 v62, v150, v174, v175
    v_fma_f32 v63, v151, v174, v175
    v_mfma_f32_16x16x32_bf16 v[108:111], v[244:247], a[92:95], v[108:111]
    ds_read_b128 v[244:247], v11 offset:20480
    s_add_u32 m0, s63, 72960
    s_waitcnt lgkmcnt(4)
    v_mfma_f32_16x16x32_bf16 v[100:103], a[96:99], v[216:219], v[100:103]
    buffer_load_dwordx4 v12, s[44:47], s82 offen offset:768 sc1 lds
    v_mfma_f32_16x16x32_bf16 v[104:107], a[100:103], v[216:219], v[104:107]
    v_fma_f32 v64, v152, v176, v177
    s_add_u32 s82, s82, 16384
    v_mfma_f32_16x16x32_bf16 v[108:111], v[216:219], a[104:107], v[108:111]
    s_waitcnt vmcnt(11)
    s_barrier
    ds_read_b128 v[216:219], v4 offset:4096
    s_add_u32 m0, s63, 16384
    v_mfma_f32_16x16x32_bf16 v[100:103], a[108:111], v[220:223], v[100:103]
    buffer_load_dwordx4 v12, s[44:47], s82 offen offset:0 sc1 lds
    v_mfma_f32_16x16x32_bf16 v[104:107], a[112:115], v[220:223], v[104:107]
    v_fma_f32 v65, v153, v176, v177
    v_fma_f32 v66, v154, v176, v177
    v_mfma_f32_16x16x32_bf16 v[108:111], v[220:223], a[116:119], v[108:111]
    ds_read_b128 v[220:223], v5 offset:4096
    s_add_u32 m0, s63, 36608
    v_mfma_f32_16x16x32_bf16 v[100:103], a[120:123], v[224:227], v[100:103]
    buffer_load_dwordx4 v12, s[44:47], s82 offen offset:256 sc1 lds
    v_mfma_f32_16x16x32_bf16 v[104:107], a[124:127], v[224:227], v[104:107]
    v_fma_f32 v67, v155, v176, v177
    v_fma_f32 v68, v156, v178, v179
    v_mfma_f32_16x16x32_bf16 v[108:111], v[224:227], a[128:131], v[108:111]
    ds_read_b128 v[224:227], v6 offset:4096
    s_add_u32 m0, s63, 56832
    v_mfma_f32_16x16x32_bf16 v[100:103], a[132:135], v[228:231], v[100:103]
    buffer_load_dwordx4 v12, s[44:47], s82 offen offset:512 sc1 lds
    v_mfma_f32_16x16x32_bf16 v[104:107], a[136:139], v[228:231], v[104:107]
    v_fma_f32 v69, v157, v178, v179
    v_mfma_f32_16x16x32_bf16 v[108:111], v[228:231], a[140:143], v[108:111]
    ds_read_b128 v[228:231], v7 offset:4096
    s_add_u32 m0, s63, 77056
    s_waitcnt lgkmcnt(4)
    v_mfma_f32_16x16x32_bf16 v[100:103], a[144:147], v[232:235], v[100:103]
    buffer_load_dwordx4 v12, s[44:47], s82 offen offset:768 sc1 lds
    v_mfma_f32_16x16x32_bf16 v[104:107], a[148:151], v[232:235], v[104:107]
    v_fma_f32 v70, v158, v178, v179
    v_mfma_f32_16x16x32_bf16 v[108:111], v[232:235], a[152:155], v[108:111]
    ds_read_b128 v[232:235], v4 offset:24576
    v_fma_f32 v71, v159, v178, v179
    v_mfma_f32_16x16x32_bf16 v[100:103], a[156:159], v[236:239], v[100:103]
    s_waitcnt lgkmcnt(0)
    s_barrier
    v_mfma_f32_16x16x32_bf16 v[104:107], a[160:163], v[236:239], v[104:107]
    v_mfma_f32_16x16x32_bf16 v[108:111], v[236:239], a[164:167], v[108:111]
    ds_read_b128 v[236:239], v5 offset:24576
    v_mfma_f32_16x16x32_bf16 v[100:103], a[168:171], v[240:243], v[100:103]
    v_mfma_f32_16x16x32_bf16 v[104:107], a[172:175], v[240:243], v[104:107]
    v_mfma_f32_16x16x32_bf16 v[108:111], v[240:243], a[176:179], v[108:111]
    ds_read_b128 v[240:243], v6 offset:24576
    v_mfma_f32_16x16x32_bf16 v[100:103], a[180:183], v[244:247], v[100:103]
    v_mfma_f32_16x16x32_bf16 v[104:107], a[184:187], v[244:247], v[104:107]
    v_mfma_f32_16x16x32_bf16 v[108:111], v[244:247], a[188:191], v[108:111]
    ds_read_b128 v[244:247], v7 offset:24576
    ds_read2_b32 v[160:161], v252 offset0:0 offset1:96
    ds_read_b128 v[162:165], v253 offset:0
    ds_read_b128 v[166:169], v253 offset:384
    v_mfma_f32_16x16x32_bf16 v[112:115], a[0:3], v[216:219], 0
    v_mfma_f32_16x16x32_bf16 v[116:119], a[4:7], v[216:219], 0
    v_mfma_f32_16x16x32_bf16 v[120:123], v[216:219], a[8:11], 0
    ds_read_b128 v[216:219], v8 offset:4096
    s_waitcnt lgkmcnt(3)
    v_fma_f32 v180, v36, v161, v100
    v_mfma_f32_16x16x32_bf16 v[112:115], a[12:15], v[220:223], v[112:115]
    v_fma_f32 v181, v37, v161, v101
    v_fma_f32 v182, v38, v161, v102
    v_mfma_f32_16x16x32_bf16 v[116:119], a[16:19], v[220:223], v[116:119]
    v_fma_f32 v183, v39, v161, v103
    v_fma_f32 v184, v40, v161, v104
    v_mfma_f32_16x16x32_bf16 v[120:123], v[220:223], a[20:23], v[120:123]
    ds_read_b128 v[220:223], v9 offset:4096
    v_fma_f32 v185, v41, v161, v105
    v_mfma_f32_16x16x32_bf16 v[112:115], a[24:27], v[224:227], v[112:115]
    v_fma_f32 v186, v42, v161, v106
    v_fma_f32 v187, v43, v161, v107
    v_mfma_f32_16x16x32_bf16 v[116:119], a[28:31], v[224:227], v[116:119]
    v_cvt_pk_bf16_f32 v192, v180, v181
    v_cvt_pk_bf16_f32 v193, v182, v183
    v_mfma_f32_16x16x32_bf16 v[120:123], v[224:227], a[32:35], v[120:123]
    ds_read_b128 v[224:227], v10 offset:4096
    v_mul_f32 v184, v184, v160
    v_mfma_f32_16x16x32_bf16 v[112:115], a[36:39], v[228:231], v[112:115]
    ds_read_b32 v72, v19
    v_mul_f32 v185, v185, v160
    v_mfma_f32_16x16x32_bf16 v[116:119], a[40:43], v[228:231], v[116:119]
    v_mul_f32 v186, v186, v160
    v_mul_f32 v187, v187, v160
    v_mfma_f32_16x16x16_bf16 v[198:201], v[86:87], v[192:193], v[32:35]
    v_cvt_pk_bf16_f32 v194, v184, v185
    v_cvt_pk_bf16_f32 v195, v186, v187
    v_mfma_f32_16x16x32_bf16 v[120:123], v[228:231], a[44:47], v[120:123]
    ds_read_b128 v[228:231], v11 offset:4096
    v_mul_f32 v206, s79, v160
    v_mfma_f32_16x16x16_bf16 v[202:205], v[194:195], v[192:193], v[24:27]
    s_waitcnt lgkmcnt(4)
    v_fma_f32 v188, v166, v44, v108
    v_mfma_f32_16x16x32_bf16 v[112:115], a[48:51], v[232:235], v[112:115]
    v_fma_f32 v189, v167, v44, v109
    v_fma_f32 v190, v168, v44, v110
    v_mfma_f32_16x16x32_bf16 v[116:119], a[52:55], v[232:235], v[116:119]
    v_fma_f32 v191, v169, v44, v111
    v_mul_f32 v188, v188, v162
    v_mfma_f32_16x16x32_bf16 v[120:123], v[232:235], a[56:59], v[120:123]
    ds_read_b128 v[232:235], v8 offset:24576
    v_mul_f32 v189, v189, v163
    v_mfma_f32_16x16x32_bf16 v[112:115], a[60:63], v[236:239], v[112:115]
    v_mul_f32 v190, v190, v164
    v_mul_f32 v191, v191, v165
    v_mfma_f32_16x16x32_bf16 v[116:119], a[64:67], v[236:239], v[116:119]
    v_max_f32 v198, v198, v202
    v_max_f32 v199, v199, v203
    v_mfma_f32_16x16x32_bf16 v[120:123], v[236:239], a[68:71], v[120:123]
    ds_read_b128 v[236:239], v9 offset:24576
    v_max_f32 v200, v200, v204
    v_mfma_f32_16x16x32_bf16 v[112:115], a[72:75], v[240:243], v[112:115]
    v_max_f32 v201, v201, v205
    v_max3_f32 v208, v198, v199, v200
    v_mfma_f32_16x16x32_bf16 v[116:119], a[76:79], v[240:243], v[116:119]
    v_max_f32 v208, v208, v201
    v_mov_b32 v209, v208
    v_mfma_f32_16x16x32_bf16 v[120:123], v[240:243], a[80:83], v[120:123]
    ds_read_b128 v[240:243], v10 offset:24576
    v_cvt_pk_bf16_f32 v88, v188, v189
    v_mfma_f32_16x16x32_bf16 v[112:115], a[84:87], v[244:247], v[112:115]
    v_permlane16_swap_b32 v208, v209
    v_mfma_f32_16x16x32_bf16 v[116:119], a[88:91], v[244:247], v[116:119]
    v_max_f32 v208, v208, v209
    v_mov_b32 v209, v208
    v_mfma_f32_16x16x32_bf16 v[120:123], v[244:247], a[92:95], v[120:123]
    ds_read_b128 v[244:247], v11 offset:24576
    v_cvt_pk_bf16_f32 v89, v190, v191
    v_mfma_f32_16x16x32_bf16 v[112:115], a[96:99], v[216:219], v[112:115]
    v_permlane32_swap_b32 v208, v209
    v_mfma_f32_16x16x32_bf16 v[116:119], a[100:103], v[216:219], v[116:119]
    v_max_f32 v208, v208, v209
    v_mul_f32 v207, v208, v206
    v_mfma_f32_16x16x32_bf16 v[120:123], v[216:219], a[104:107], v[120:123]
    s_waitcnt vmcnt(0)
    s_barrier
    ds_read_b128 v[216:219], v4 offset:8192
    v_fma_f32 v198, v198, v206, -v207
    s_waitcnt lgkmcnt(3)
    v_mfma_f32_16x16x32_bf16 v[112:115], a[108:111], v[220:223], v[112:115]
    v_fma_f32 v199, v199, v206, -v207
    v_fma_f32 v200, v200, v206, -v207
    v_mfma_f32_16x16x32_bf16 v[116:119], a[112:115], v[220:223], v[116:119]
    v_fma_f32 v201, v201, v206, -v207
    v_mfma_f32_16x16x32_bf16 v[120:123], v[220:223], a[116:119], v[120:123]
    ds_read_b128 v[220:223], v5 offset:8192
    v_mfma_f32_16x16x32_bf16 v[112:115], a[120:123], v[224:227], v[112:115]
    v_exp_f32 v198, v198
    v_mfma_f32_16x16x32_bf16 v[116:119], a[124:127], v[224:227], v[116:119]
    v_exp_f32 v199, v199
    v_mfma_f32_16x16x32_bf16 v[120:123], v[224:227], a[128:131], v[120:123]
    ds_read_b128 v[224:227], v6 offset:8192
    v_mfma_f32_16x16x32_bf16 v[112:115], a[132:135], v[228:231], v[112:115]
    v_exp_f32 v200, v200
    v_mfma_f32_16x16x32_bf16 v[116:119], a[136:139], v[228:231], v[116:119]
    v_exp_f32 v201, v201
    v_mfma_f32_16x16x32_bf16 v[120:123], v[228:231], a[140:143], v[120:123]
    ds_read_b128 v[228:231], v7 offset:8192
    v_cvt_pk_bf16_f32 v198, v198, v199
    v_mfma_f32_16x16x32_bf16 v[112:115], a[144:147], v[232:235], v[112:115]
    v_cvt_pk_bf16_f32 v199, v200, v201
    v_mfma_f32_16x16x32_bf16 v[116:119], a[148:151], v[232:235], v[116:119]
    buffer_store_dword v72, v82, s[44:47], s22 offen sc1
    v_mfma_f32_16x16x32_bf16 v[120:123], v[232:235], a[152:155], v[120:123]
    ds_read_b128 v[232:235], v4 offset:28672
    v_and_b32 v210, v248, v198
    v_mfma_f32_16x16x32_bf16 v[112:115], a[156:159], v[236:239], v[112:115]
    v_and_b32 v211, v249, v199
    v_and_b32 v212, v250, v198
    v_mfma_f32_16x16x32_bf16 v[116:119], a[160:163], v[236:239], v[116:119]
    v_and_b32 v213, v251, v199
    v_mfma_f32_16x16x16_bf16 v[202:205], v[20:21], v[198:199], 0
    v_mfma_f32_16x16x32_bf16 v[120:123], v[236:239], a[164:167], v[120:123]
    ds_read_b128 v[236:239], v5 offset:28672
    v_mfma_f32_16x16x32_bf16 v[180:183], v[86:89], v[210:213], 0
    ds_read_b128 v[78:81], v85
    s_waitcnt lgkmcnt(5)
    v_mfma_f32_16x16x32_bf16 v[112:115], a[168:171], v[240:243], v[112:115]
    ds_read_b128 v[74:77], v98
    v_mfma_f32_16x16x32_bf16 v[116:119], a[172:175], v[240:243], v[116:119]
    v_mfma_f32_16x16x32_bf16 v[120:123], v[240:243], a[176:179], v[120:123]
    ds_read_b128 v[240:243], v6 offset:28672
    v_mfma_f32_16x16x32_bf16 v[112:115], a[180:183], v[244:247], v[112:115]
    v_mfma_f32_16x16x32_bf16 v[116:119], a[184:187], v[244:247], v[116:119]
    s_waitcnt lgkmcnt(2)
    buffer_store_dwordx4 v[78:81], v16, s[44:47], s19 offen sc1
    v_mfma_f32_16x16x32_bf16 v[120:123], v[244:247], a[188:191], v[120:123]
    ds_read_b128 v[244:247], v7 offset:28672
    s_waitcnt lgkmcnt(2)
    buffer_store_dwordx4 v[74:77], v16, s[44:47], s20 offen sc1
    ds_read2_b32 v[160:161], v252 offset0:16 offset1:112
    ds_read_b128 v[162:165], v253 offset:64
    ds_read_b128 v[166:169], v253 offset:448
    v_mfma_f32_16x16x32_bf16 v[124:127], a[0:3], v[216:219], 0
    v_mfma_f32_16x16x32_bf16 v[128:131], a[4:7], v[216:219], 0
    v_mfma_f32_16x16x32_bf16 v[132:135], v[216:219], a[8:11], 0
    ds_read_b128 v[216:219], v8 offset:8192
    v_mfma_f32_16x16x32_bf16 v[124:127], a[12:15], v[220:223], v[124:127]
    v_rcp_f32 v202, v202
    v_mfma_f32_16x16x32_bf16 v[128:131], a[16:19], v[220:223], v[128:131]
    v_mul_f32 v180, v180, v202
    v_mfma_f32_16x16x32_bf16 v[132:135], v[220:223], a[20:23], v[132:135]
    ds_read_b128 v[220:223], v9 offset:8192
    ds_read_b128 v[78:81], v99
    v_mfma_f32_16x16x32_bf16 v[124:127], a[24:27], v[224:227], v[124:127]
    v_mul_f32 v181, v181, v202
    v_mul_f32 v182, v182, v202
    v_mfma_f32_16x16x32_bf16 v[128:131], a[28:31], v[224:227], v[128:131]
    v_mul_f32 v183, v183, v202
    v_cvt_pk_bf16_f32 v170, v180, v181
    v_mfma_f32_16x16x32_bf16 v[132:135], v[224:227], a[32:35], v[132:135]
    ds_read_b128 v[224:227], v10 offset:8192
    v_mfma_f32_16x16x32_bf16 v[124:127], a[36:39], v[228:231], v[124:127]
    v_mfma_f32_16x16x32_bf16 v[128:131], a[40:43], v[228:231], v[128:131]
    s_waitcnt lgkmcnt(1)
    buffer_store_dwordx4 v[78:81], v16, s[44:47], s21 offen sc1
    v_mfma_f32_16x16x32_bf16 v[132:135], v[228:231], a[44:47], v[132:135]
    ds_read_b128 v[228:231], v11 offset:8192
    v_cvt_pk_bf16_f32 v171, v182, v183
    v_mfma_f32_16x16x32_bf16 v[124:127], a[48:51], v[232:235], v[124:127]
    s_add_u32 s53, s85, 0
    s_mov_b64 exec, s[28:29]
    buffer_store_dwordx2 v[170:171], v13, s[44:47], s53 offen
    s_mov_b64 exec, s[16:17]
    buffer_store_dwordx2 v[170:171], v13, s[44:47], s53 offen  sc1
    s_mov_b64 exec, -1
    v_mfma_f32_16x16x32_bf16 v[128:131], a[52:55], v[232:235], v[128:131]
    v_fma_f32 v180, v36, v161, v112
    v_fma_f32 v181, v37, v161, v113
    v_mfma_f32_16x16x32_bf16 v[132:135], v[232:235], a[56:59], v[132:135]
    ds_read_b128 v[232:235], v8 offset:28672
    v_fma_f32 v182, v38, v161, v114
    v_mfma_f32_16x16x32_bf16 v[124:127], a[60:63], v[236:239], v[124:127]
    v_fma_f32 v183, v39, v161, v115
    v_fma_f32 v184, v40, v161, v116
    v_mfma_f32_16x16x32_bf16 v[128:131], a[64:67], v[236:239], v[128:131]
    v_fma_f32 v185, v41, v161, v117
    v_fma_f32 v186, v42, v161, v118
    v_mfma_f32_16x16x32_bf16 v[132:135], v[236:239], a[68:71], v[132:135]
    ds_read_b128 v[236:239], v9 offset:28672
    v_fma_f32 v187, v43, v161, v119
    v_mfma_f32_16x16x32_bf16 v[124:127], a[72:75], v[240:243], v[124:127]
    v_cvt_pk_bf16_f32 v192, v180, v181
    v_cvt_pk_bf16_f32 v193, v182, v183
    v_mfma_f32_16x16x32_bf16 v[128:131], a[76:79], v[240:243], v[128:131]
    v_mul_f32 v184, v184, v160
    v_mul_f32 v185, v185, v160
    v_mfma_f32_16x16x32_bf16 v[132:135], v[240:243], a[80:83], v[132:135]
    ds_read_b128 v[240:243], v10 offset:28672
    v_mul_f32 v186, v186, v160
    v_mfma_f32_16x16x32_bf16 v[124:127], a[84:87], v[244:247], v[124:127]
    v_mul_f32 v187, v187, v160
    v_mfma_f32_16x16x16_bf16 v[198:201], v[194:195], v[192:193], v[28:31]
    v_cvt_pk_bf16_f32 v196, v184, v185
    v_cvt_pk_bf16_f32 v197, v186, v187
    v_mfma_f32_16x16x32_bf16 v[128:131], a[88:91], v[244:247], v[128:131]
    v_mul_f32 v206, s79, v160
    v_mfma_f32_16x16x16_bf16 v[202:205], v[196:197], v[192:193], v[24:27]
    v_fma_f32 v188, v166, v44, v120
    v_fma_f32 v189, v167, v44, v121
    v_mfma_f32_16x16x32_bf16 v[132:135], v[244:247], a[92:95], v[132:135]
    ds_read_b128 v[244:247], v11 offset:28672
    v_fma_f32 v190, v168, v44, v122
    v_mfma_f32_16x16x32_bf16 v[124:127], a[96:99], v[216:219], v[124:127]
    v_fma_f32 v191, v169, v44, v123
    v_mul_f32 v188, v188, v162
    v_mfma_f32_16x16x32_bf16 v[128:131], a[100:103], v[216:219], v[128:131]
    v_mul_f32 v189, v189, v163
    v_mul_f32 v190, v190, v164
    v_mfma_f32_16x16x32_bf16 v[132:135], v[216:219], a[104:107], v[132:135]
    ds_read_b128 v[216:219], v4 offset:12288
    v_mul_f32 v191, v191, v165
    v_mfma_f32_16x16x32_bf16 v[124:127], a[108:111], v[220:223], v[124:127]
    v_max_f32 v198, v198, v202
    v_max_f32 v199, v199, v203
    v_mfma_f32_16x16x32_bf16 v[128:131], a[112:115], v[220:223], v[128:131]
    v_max_f32 v200, v200, v204
    v_max_f32 v201, v201, v205
    v_mfma_f32_16x16x32_bf16 v[132:135], v[220:223], a[116:119], v[132:135]
    ds_read_b128 v[220:223], v5 offset:12288
    v_max3_f32 v208, v198, v199, v200
    s_waitcnt lgkmcnt(3)
    v_mfma_f32_16x16x32_bf16 v[124:127], a[120:123], v[224:227], v[124:127]
    v_max_f32 v208, v208, v201
    v_mov_b32 v209, v208
    v_mfma_f32_16x16x32_bf16 v[128:131], a[124:127], v[224:227], v[128:131]
    v_cvt_pk_bf16_f32 v90, v188, v189
    v_permlane16_swap_b32 v208, v209
    v_mfma_f32_16x16x32_bf16 v[132:135], v[224:227], a[128:131], v[132:135]
    ds_read_b128 v[224:227], v6 offset:12288
    v_max_f32 v208, v208, v209
    v_mfma_f32_16x16x32_bf16 v[124:127], a[132:135], v[228:231], v[124:127]
    v_mov_b32 v209, v208
    v_cvt_pk_bf16_f32 v91, v190, v191
    v_mfma_f32_16x16x32_bf16 v[128:131], a[136:139], v[228:231], v[128:131]
    v_permlane32_swap_b32 v208, v209
    v_mfma_f32_16x16x32_bf16 v[132:135], v[228:231], a[140:143], v[132:135]
    ds_read_b128 v[228:231], v7 offset:12288
    v_max_f32 v208, v208, v209
    v_mfma_f32_16x16x32_bf16 v[124:127], a[144:147], v[232:235], v[124:127]
    v_mul_f32 v207, v208, v206
    v_fma_f32 v198, v198, v206, -v207
    v_mfma_f32_16x16x32_bf16 v[128:131], a[148:151], v[232:235], v[128:131]
    v_fma_f32 v199, v199, v206, -v207
    v_fma_f32 v200, v200, v206, -v207
    v_mfma_f32_16x16x32_bf16 v[132:135], v[232:235], a[152:155], v[132:135]
    ds_read_b128 v[232:235], v4 offset:32768
    v_fma_f32 v201, v201, v206, -v207
    v_mfma_f32_16x16x32_bf16 v[124:127], a[156:159], v[236:239], v[124:127]
    v_exp_f32 v198, v198
    v_mfma_f32_16x16x32_bf16 v[128:131], a[160:163], v[236:239], v[128:131]
    v_exp_f32 v199, v199
    v_mfma_f32_16x16x32_bf16 v[132:135], v[236:239], a[164:167], v[132:135]
    ds_read_b128 v[236:239], v5 offset:32768
    v_mov_b32 v72, s90
    v_mfma_f32_16x16x32_bf16 v[124:127], a[168:171], v[240:243], v[124:127]
    v_exp_f32 v200, v200
    v_mfma_f32_16x16x32_bf16 v[128:131], a[172:175], v[240:243], v[128:131]
    v_exp_f32 v201, v201
    v_mfma_f32_16x16x32_bf16 v[132:135], v[240:243], a[176:179], v[132:135]
    ds_read_b128 v[240:243], v6 offset:32768
    v_mov_b32 v73, s65
    s_waitcnt lgkmcnt(4)
    v_mfma_f32_16x16x32_bf16 v[124:127], a[180:183], v[244:247], v[124:127]
    v_cvt_pk_bf16_f32 v198, v198, v199
    v_cvt_pk_bf16_f32 v199, v200, v201
    v_mfma_f32_16x16x32_bf16 v[128:131], a[184:187], v[244:247], v[128:131]
    v_and_b32 v210, v248, v198
    s_add_u32 s55, s72, 267520
    v_mfma_f32_16x16x32_bf16 v[132:135], v[244:247], a[188:191], v[132:135]
    ds_read_b128 v[244:247], v7 offset:32768
    v_and_b32 v211, v249, v199
    v_and_b32 v212, v250, v198
    s_waitcnt vmcnt(2)
    v_and_b32 v213, v251, v199
    v_mfma_f32_16x16x16_bf16 v[202:205], v[20:21], v[198:199], 0
    s_mov_b64 exec, 1
    buffer_store_dword v72, v73, s[44:47], s55 offen sc1
    s_mov_b64 exec, -1
    v_mfma_f32_16x16x32_bf16 v[180:183], v[88:91], v[210:213], 0
    ds_read2_b32 v[160:161], v252 offset0:32 offset1:128
    ds_read_b128 v[162:165], v253 offset:128
    ds_read_b128 v[166:169], v253 offset:512
    v_mfma_f32_16x16x32_bf16 v[136:139], a[0:3], v[216:219], 0
    v_mfma_f32_16x16x32_bf16 v[140:143], a[4:7], v[216:219], 0
    v_mfma_f32_16x16x32_bf16 v[144:147], v[216:219], a[8:11], 0
    ds_read_b128 v[216:219], v8 offset:12288
    v_mfma_f32_16x16x32_bf16 v[136:139], a[12:15], v[220:223], v[136:139]
    v_rcp_f32 v202, v202
    v_mfma_f32_16x16x32_bf16 v[140:143], a[16:19], v[220:223], v[140:143]
    v_mul_f32 v180, v180, v202
    v_mul_f32 v181, v181, v202
    v_mfma_f32_16x16x32_bf16 v[144:147], v[220:223], a[20:23], v[144:147]
    ds_read_b128 v[220:223], v9 offset:12288
    v_mul_f32 v182, v182, v202
    v_mfma_f32_16x16x32_bf16 v[136:139], a[24:27], v[224:227], v[136:139]
    v_mul_f32 v183, v183, v202
    v_cvt_pk_bf16_f32 v172, v180, v181
    v_mfma_f32_16x16x32_bf16 v[140:143], a[28:31], v[224:227], v[140:143]
    v_cvt_pk_bf16_f32 v173, v182, v183
    s_add_u32 s53, s85, 16384
    v_mfma_f32_16x16x32_bf16 v[144:147], v[224:227], a[32:35], v[144:147]
    ds_read_b128 v[224:227], v10 offset:12288
    s_waitcnt lgkmcnt(6)
    v_mfma_f32_16x16x32_bf16 v[136:139], a[36:39], v[228:231], v[136:139]
    s_mov_b64 exec, s[28:29]
    buffer_store_dwordx2 v[172:173], v13, s[44:47], s53 offen
    s_mov_b64 exec, s[16:17]
    buffer_store_dwordx2 v[172:173], v13, s[44:47], s53 offen  sc1
    s_mov_b64 exec, -1
    v_mfma_f32_16x16x32_bf16 v[140:143], a[40:43], v[228:231], v[140:143]
    s_waitcnt lgkmcnt(3)
    v_fma_f32 v180, v36, v161, v124
    v_fma_f32 v181, v37, v161, v125
    v_mfma_f32_16x16x32_bf16 v[144:147], v[228:231], a[44:47], v[144:147]
    ds_read_b128 v[228:231], v11 offset:12288
    v_fma_f32 v182, v38, v161, v126
    v_mfma_f32_16x16x32_bf16 v[136:139], a[48:51], v[232:235], v[136:139]
    v_fma_f32 v183, v39, v161, v127
    v_fma_f32 v184, v40, v161, v128
    v_mfma_f32_16x16x32_bf16 v[140:143], a[52:55], v[232:235], v[140:143]
    v_fma_f32 v185, v41, v161, v129
    v_fma_f32 v186, v42, v161, v130
    v_mfma_f32_16x16x32_bf16 v[144:147], v[232:235], a[56:59], v[144:147]
    ds_read_b128 v[232:235], v8 offset:32768
    v_fma_f32 v187, v43, v161, v131
    v_mfma_f32_16x16x32_bf16 v[136:139], a[60:63], v[236:239], v[136:139]
    v_cvt_pk_bf16_f32 v192, v180, v181
    v_cvt_pk_bf16_f32 v193, v182, v183
    v_mfma_f32_16x16x32_bf16 v[140:143], a[64:67], v[236:239], v[140:143]
    v_mul_f32 v184, v184, v160
    v_mul_f32 v185, v185, v160
    v_mfma_f32_16x16x32_bf16 v[144:147], v[236:239], a[68:71], v[144:147]
    ds_read_b128 v[236:239], v9 offset:32768
    v_mul_f32 v186, v186, v160
    v_mfma_f32_16x16x32_bf16 v[136:139], a[72:75], v[240:243], v[136:139]
    v_mul_f32 v187, v187, v160
    v_mfma_f32_16x16x16_bf16 v[198:201], v[196:197], v[192:193], v[28:31]
    v_cvt_pk_bf16_f32 v194, v184, v185
    v_cvt_pk_bf16_f32 v195, v186, v187
    v_mfma_f32_16x16x32_bf16 v[140:143], a[76:79], v[240:243], v[140:143]
    v_mul_f32 v206, s79, v160
    v_mfma_f32_16x16x16_bf16 v[202:205], v[194:195], v[192:193], v[24:27]
    v_fma_f32 v188, v166, v44, v132
    v_fma_f32 v189, v167, v44, v133
    v_mfma_f32_16x16x32_bf16 v[144:147], v[240:243], a[80:83], v[144:147]
    ds_read_b128 v[240:243], v10 offset:32768
    v_fma_f32 v190, v168, v44, v134
    v_mfma_f32_16x16x32_bf16 v[136:139], a[84:87], v[244:247], v[136:139]
    v_fma_f32 v191, v169, v44, v135
    v_mul_f32 v188, v188, v162
    v_mfma_f32_16x16x32_bf16 v[140:143], a[88:91], v[244:247], v[140:143]
    v_mul_f32 v189, v189, v163
    v_mul_f32 v190, v190, v164
    v_mfma_f32_16x16x32_bf16 v[144:147], v[244:247], a[92:95], v[144:147]
    ds_read_b128 v[244:247], v11 offset:32768
    v_mul_f32 v191, v191, v165
    s_waitcnt lgkmcnt(3)
    v_mfma_f32_16x16x32_bf16 v[136:139], a[96:99], v[216:219], v[136:139]
    v_max_f32 v198, v198, v202
    v_max_f32 v199, v199, v203
    v_mfma_f32_16x16x32_bf16 v[140:143], a[100:103], v[216:219], v[140:143]
    v_max_f32 v200, v200, v204
    v_max_f32 v201, v201, v205
    v_mfma_f32_16x16x32_bf16 v[144:147], v[216:219], a[104:107], v[144:147]
    ds_read_b128 v[216:219], v4 offset:16384
    v_max3_f32 v208, v198, v199, v200
    v_mfma_f32_16x16x32_bf16 v[136:139], a[108:111], v[220:223], v[136:139]
    v_max_f32 v208, v208, v201
    v_mov_b32 v209, v208
    v_mfma_f32_16x16x32_bf16 v[140:143], a[112:115], v[220:223], v[140:143]
    v_cvt_pk_bf16_f32 v92, v188, v189
    v_mfma_f32_16x16x32_bf16 v[144:147], v[220:223], a[116:119], v[144:147]
    ds_read_b128 v[220:223], v5 offset:16384
    v_mfma_f32_16x16x32_bf16 v[136:139], a[120:123], v[224:227], v[136:139]
    v_permlane16_swap_b32 v208, v209
    v_mfma_f32_16x16x32_bf16 v[140:143], a[124:127], v[224:227], v[140:143]
    v_max_f32 v208, v208, v209
    v_mov_b32 v209, v208
    v_mfma_f32_16x16x32_bf16 v[144:147], v[224:227], a[128:131], v[144:147]
    ds_read_b128 v[224:227], v6 offset:16384
    v_cvt_pk_bf16_f32 v93, v190, v191
    v_mfma_f32_16x16x32_bf16 v[136:139], a[132:135], v[228:231], v[136:139]
    v_permlane32_swap_b32 v208, v209
    v_mfma_f32_16x16x32_bf16 v[140:143], a[136:139], v[228:231], v[140:143]
    v_max_f32 v208, v208, v209
    v_mul_f32 v207, v208, v206
    v_mfma_f32_16x16x32_bf16 v[144:147], v[228:231], a[140:143], v[144:147]
    ds_read_b128 v[228:231], v7 offset:16384
    v_fma_f32 v198, v198, v206, -v207
    v_mfma_f32_16x16x32_bf16 v[136:139], a[144:147], v[232:235], v[136:139]
    v_fma_f32 v199, v199, v206, -v207
    v_fma_f32 v200, v200, v206, -v207
    v_mfma_f32_16x16x32_bf16 v[140:143], a[148:151], v[232:235], v[140:143]
    v_fma_f32 v201, v201, v206, -v207
    v_mfma_f32_16x16x32_bf16 v[144:147], v[232:235], a[152:155], v[144:147]
    ds_read_b128 v[232:235], v4 offset:36864
    s_waitcnt lgkmcnt(4)
    v_mfma_f32_16x16x32_bf16 v[136:139], a[156:159], v[236:239], v[136:139]
    v_exp_f32 v198, v198
    v_mfma_f32_16x16x32_bf16 v[140:143], a[160:163], v[236:239], v[140:143]
    v_exp_f32 v199, v199
    v_mfma_f32_16x16x32_bf16 v[144:147], v[236:239], a[164:167], v[144:147]
    ds_read_b128 v[236:239], v5 offset:36864
    v_mfma_f32_16x16x32_bf16 v[136:139], a[168:171], v[240:243], v[136:139]
    v_exp_f32 v200, v200
    v_mfma_f32_16x16x32_bf16 v[140:143], a[172:175], v[240:243], v[140:143]
    v_exp_f32 v201, v201
    v_mfma_f32_16x16x32_bf16 v[144:147], v[240:243], a[176:179], v[144:147]
    ds_read_b128 v[240:243], v6 offset:36864
    v_cvt_pk_bf16_f32 v198, v198, v199
    v_mfma_f32_16x16x32_bf16 v[136:139], a[180:183], v[244:247], v[136:139]
    v_cvt_pk_bf16_f32 v199, v200, v201
    v_and_b32 v210, v248, v198
    v_mfma_f32_16x16x32_bf16 v[140:143], a[184:187], v[244:247], v[140:143]
    v_and_b32 v211, v249, v199
    v_and_b32 v212, v250, v198
    v_mfma_f32_16x16x32_bf16 v[144:147], v[244:247], a[188:191], v[144:147]
    ds_read_b128 v[244:247], v7 offset:36864
    v_and_b32 v213, v251, v199
    v_mfma_f32_16x16x16_bf16 v[202:205], v[20:21], v[198:199], 0
    s_nop 0
    v_mfma_f32_16x16x32_bf16 v[180:183], v[90:93], v[210:213], 0
    ds_read2_b32 v[160:161], v252 offset0:48 offset1:144
    ds_read_b128 v[162:165], v253 offset:192
    ds_read_b128 v[166:169], v253 offset:576
    v_mfma_f32_16x16x32_bf16 v[148:151], a[0:3], v[216:219], 0
    v_mfma_f32_16x16x32_bf16 v[152:155], a[4:7], v[216:219], 0
    v_mfma_f32_16x16x32_bf16 v[156:159], v[216:219], a[8:11], 0
    ds_read_b128 v[216:219], v8 offset:16384
    s_waitcnt lgkmcnt(7)
    v_mfma_f32_16x16x32_bf16 v[148:151], a[12:15], v[220:223], v[148:151]
    v_rcp_f32 v202, v202
    v_mfma_f32_16x16x32_bf16 v[152:155], a[16:19], v[220:223], v[152:155]
    v_mul_f32 v180, v180, v202
    v_mul_f32 v181, v181, v202
    v_mfma_f32_16x16x32_bf16 v[156:159], v[220:223], a[20:23], v[156:159]
    ds_read_b128 v[220:223], v9 offset:16384
    v_mul_f32 v182, v182, v202
    v_mfma_f32_16x16x32_bf16 v[148:151], a[24:27], v[224:227], v[148:151]
    v_mul_f32 v183, v183, v202
    v_cvt_pk_bf16_f32 v174, v180, v181
    v_mfma_f32_16x16x32_bf16 v[152:155], a[28:31], v[224:227], v[152:155]
    v_cvt_pk_bf16_f32 v175, v182, v183
    s_add_u32 s53, s85, 32768
    v_mfma_f32_16x16x32_bf16 v[156:159], v[224:227], a[32:35], v[156:159]
    ds_read_b128 v[224:227], v10 offset:16384
    v_mfma_f32_16x16x32_bf16 v[148:151], a[36:39], v[228:231], v[148:151]
    s_mov_b64 exec, s[28:29]
    buffer_store_dwordx2 v[174:175], v13, s[44:47], s53 offen
    s_mov_b64 exec, s[16:17]
    buffer_store_dwordx2 v[174:175], v13, s[44:47], s53 offen  sc1
    s_mov_b64 exec, -1
    v_mfma_f32_16x16x32_bf16 v[152:155], a[40:43], v[228:231], v[152:155]
    s_waitcnt lgkmcnt(3)
    v_fma_f32 v180, v36, v161, v136
    v_fma_f32 v181, v37, v161, v137
    v_mfma_f32_16x16x32_bf16 v[156:159], v[228:231], a[44:47], v[156:159]
    ds_read_b128 v[228:231], v11 offset:16384
    v_fma_f32 v182, v38, v161, v138
    v_mfma_f32_16x16x32_bf16 v[148:151], a[48:51], v[232:235], v[148:151]
    v_fma_f32 v183, v39, v161, v139
    v_fma_f32 v184, v40, v161, v140
    v_mfma_f32_16x16x32_bf16 v[152:155], a[52:55], v[232:235], v[152:155]
    v_fma_f32 v185, v41, v161, v141
    v_fma_f32 v186, v42, v161, v142
    v_mfma_f32_16x16x32_bf16 v[156:159], v[232:235], a[56:59], v[156:159]
    ds_read_b128 v[232:235], v8 offset:36864
    v_fma_f32 v187, v43, v161, v143
    v_mfma_f32_16x16x32_bf16 v[148:151], a[60:63], v[236:239], v[148:151]
    v_cvt_pk_bf16_f32 v192, v180, v181
    v_cvt_pk_bf16_f32 v193, v182, v183
    v_mfma_f32_16x16x32_bf16 v[152:155], a[64:67], v[236:239], v[152:155]
    v_mul_f32 v184, v184, v160
    v_mul_f32 v185, v185, v160
    v_mfma_f32_16x16x32_bf16 v[156:159], v[236:239], a[68:71], v[156:159]
    ds_read_b128 v[236:239], v9 offset:36864
    v_mul_f32 v186, v186, v160
    v_mfma_f32_16x16x32_bf16 v[148:151], a[72:75], v[240:243], v[148:151]
    v_mul_f32 v187, v187, v160
    v_mfma_f32_16x16x16_bf16 v[198:201], v[194:195], v[192:193], v[28:31]
    v_cvt_pk_bf16_f32 v196, v184, v185
    v_cvt_pk_bf16_f32 v197, v186, v187
    v_mfma_f32_16x16x32_bf16 v[152:155], a[76:79], v[240:243], v[152:155]
    v_mul_f32 v206, s79, v160
    v_mfma_f32_16x16x16_bf16 v[202:205], v[196:197], v[192:193], v[24:27]
    v_fma_f32 v188, v166, v44, v144
    v_fma_f32 v189, v167, v44, v145
    v_mfma_f32_16x16x32_bf16 v[156:159], v[240:243], a[80:83], v[156:159]
    ds_read_b128 v[240:243], v10 offset:36864
    v_fma_f32 v190, v168, v44, v146
    v_mfma_f32_16x16x32_bf16 v[148:151], a[84:87], v[244:247], v[148:151]
    v_fma_f32 v191, v169, v44, v147
    v_mul_f32 v188, v188, v162
    v_mfma_f32_16x16x32_bf16 v[152:155], a[88:91], v[244:247], v[152:155]
    v_mul_f32 v189, v189, v163
    v_mul_f32 v190, v190, v164
    v_mfma_f32_16x16x32_bf16 v[156:159], v[244:247], a[92:95], v[156:159]
    ds_read_b128 v[244:247], v11 offset:36864
    v_mul_f32 v191, v191, v165
    s_waitcnt lgkmcnt(3)
    v_mfma_f32_16x16x32_bf16 v[148:151], a[96:99], v[216:219], v[148:151]
    v_max_f32 v198, v198, v202
    v_max_f32 v199, v199, v203
    v_mfma_f32_16x16x32_bf16 v[152:155], a[100:103], v[216:219], v[152:155]
    buffer_load_dwordx4 v[74:77], v86, s[44:47], s11 offen sc1
    v_mfma_f32_16x16x32_bf16 v[156:159], v[216:219], a[104:107], v[156:159]
    v_max_f32 v200, v200, v204
    v_max_f32 v201, v201, v205
    v_mfma_f32_16x16x32_bf16 v[148:151], a[108:111], v[220:223], v[148:151]
    v_max3_f32 v208, v198, v199, v200
    v_max_f32 v208, v208, v201
    v_mfma_f32_16x16x32_bf16 v[152:155], a[112:115], v[220:223], v[152:155]
    v_mov_b32 v209, v208
    v_cvt_pk_bf16_f32 v94, v188, v189
    v_mfma_f32_16x16x32_bf16 v[156:159], v[220:223], a[116:119], v[156:159]
    v_permlane16_swap_b32 v208, v209
    v_mfma_f32_16x16x32_bf16 v[148:151], a[120:123], v[224:227], v[148:151]
    v_max_f32 v208, v208, v209
    v_mov_b32 v209, v208
    v_mfma_f32_16x16x32_bf16 v[152:155], a[124:127], v[224:227], v[152:155]
    v_cvt_pk_bf16_f32 v95, v190, v191
    v_mfma_f32_16x16x32_bf16 v[156:159], v[224:227], a[128:131], v[156:159]
    v_permlane32_swap_b32 v208, v209
    v_mfma_f32_16x16x32_bf16 v[148:151], a[132:135], v[228:231], v[148:151]
    v_max_f32 v208, v208, v209
    v_mul_f32 v207, v208, v206
    v_mfma_f32_16x16x32_bf16 v[152:155], a[136:139], v[228:231], v[152:155]
    v_fma_f32 v198, v198, v206, -v207
    v_fma_f32 v199, v199, v206, -v207
    v_mfma_f32_16x16x32_bf16 v[156:159], v[228:231], a[140:143], v[156:159]
    v_fma_f32 v200, v200, v206, -v207
    v_fma_f32 v201, v201, v206, -v207
    v_mfma_f32_16x16x32_bf16 v[148:151], a[144:147], v[232:235], v[148:151]
    v_exp_f32 v198, v198
    v_mfma_f32_16x16x32_bf16 v[152:155], a[148:151], v[232:235], v[152:155]
    v_exp_f32 v199, v199
    v_mfma_f32_16x16x32_bf16 v[156:159], v[232:235], a[152:155], v[156:159]
    v_exp_f32 v200, v200
    s_waitcnt lgkmcnt(0)
    v_mfma_f32_16x16x32_bf16 v[148:151], a[156:159], v[236:239], v[148:151]
    v_exp_f32 v201, v201
    v_mfma_f32_16x16x32_bf16 v[152:155], a[160:163], v[236:239], v[152:155]
    v_cvt_pk_bf16_f32 v198, v198, v199
    v_cvt_pk_bf16_f32 v199, v200, v201
    v_mfma_f32_16x16x32_bf16 v[156:159], v[236:239], a[164:167], v[156:159]
    v_and_b32 v210, v248, v198
    v_and_b32 v211, v249, v199
    v_mfma_f32_16x16x32_bf16 v[148:151], a[168:171], v[240:243], v[148:151]
    v_and_b32 v212, v250, v198
    v_and_b32 v213, v251, v199
    v_mfma_f32_16x16x16_bf16 v[202:205], v[20:21], v[198:199], 0
    v_mfma_f32_16x16x32_bf16 v[152:155], a[172:175], v[240:243], v[152:155]
    v_mfma_f32_16x16x32_bf16 v[180:183], v[92:95], v[210:213], 0
    v_mfma_f32_16x16x32_bf16 v[156:159], v[240:243], a[176:179], v[156:159]
    s_nop 4
    v_rcp_f32 v202, v202
    v_mfma_f32_16x16x32_bf16 v[148:151], a[180:183], v[244:247], v[148:151]
    v_mul_f32 v180, v180, v202
    v_mul_f32 v181, v181, v202
    v_mfma_f32_16x16x32_bf16 v[152:155], a[184:187], v[244:247], v[152:155]
    v_mul_f32 v182, v182, v202
    v_mul_f32 v183, v183, v202
    v_mfma_f32_16x16x32_bf16 v[156:159], v[244:247], a[188:191], v[156:159]
    v_cvt_pk_bf16_f32 v176, v180, v181
    v_cvt_pk_bf16_f32 v177, v182, v183
    s_add_u32 s53, s85, 49152
    s_mov_b64 exec, s[28:29]
    buffer_store_dwordx2 v[176:177], v13, s[44:47], s53 offen
    s_mov_b64 exec, s[16:17]
    buffer_store_dwordx2 v[176:177], v13, s[44:47], s53 offen  sc1
    s_mov_b64 exec, -1
    ds_read2_b32 v[160:161], v252 offset0:64 offset1:160
    ds_read_b128 v[162:165], v253 offset:256
    ds_read_b128 v[166:169], v253 offset:640
    s_waitcnt lgkmcnt(2)
    v_pk_fma_f32 v[180:181], v[36:37], v[160:161], v[148:149] op_sel:[0,1,0] op_sel_hi:[1,1,1]
    v_pk_fma_f32 v[182:183], v[38:39], v[160:161], v[150:151] op_sel:[0,1,0] op_sel_hi:[1,1,1]
    v_pk_fma_f32 v[184:185], v[40:41], v[160:161], v[152:153] op_sel:[0,1,0] op_sel_hi:[1,1,1]
    v_pk_fma_f32 v[186:187], v[42:43], v[160:161], v[154:155] op_sel:[0,1,0] op_sel_hi:[1,1,1]
    v_cvt_pk_bf16_f32 v192, v180, v181
    v_cvt_pk_bf16_f32 v193, v182, v183
    v_pk_mul_f32 v[184:185], v[184:185], v[160:161] op_sel_hi:[1,0]
    v_pk_mul_f32 v[186:187], v[186:187], v[160:161] op_sel_hi:[1,0]
    v_mfma_f32_16x16x16_bf16 v[198:201], v[196:197], v[192:193], v[28:31]
    v_cvt_pk_bf16_f32 v194, v184, v185
    v_cvt_pk_bf16_f32 v195, v186, v187
    v_mul_f32 v206, s79, v160
    s_nop 0
    v_mfma_f32_16x16x16_bf16 v[202:205], v[194:195], v[192:193], v[24:27]
    s_waitcnt lgkmcnt(0)
    v_fma_f32 v188, v166, v44, v156
    v_fma_f32 v189, v167, v44, v157
    v_fma_f32 v190, v168, v44, v158
    v_fma_f32 v191, v169, v44, v159
    v_mul_f32 v188, v188, v162
    v_mul_f32 v189, v189, v163
    v_mul_f32 v190, v190, v164
    v_mul_f32 v191, v191, v165
    v_max_f32 v198, v198, v202
    v_max_f32 v199, v199, v203
    v_max_f32 v200, v200, v204
    v_max_f32 v201, v201, v205
    v_max3_f32 v208, v198, v199, v200
    v_max_f32 v208, v208, v201
    v_mov_b32 v209, v208
    v_cvt_pk_bf16_f32 v96, v188, v189
    s_nop 0
    v_permlane16_swap_b32 v208, v209
    v_max_f32 v208, v208, v209
    v_mov_b32 v209, v208
    v_cvt_pk_bf16_f32 v97, v190, v191
    s_nop 0
    v_permlane32_swap_b32 v208, v209
    v_max_f32 v208, v208, v209
    v_mul_f32 v207, v208, v206
    v_fma_f32 v198, v198, v206, -v207
    v_fma_f32 v199, v199, v206, -v207
    v_fma_f32 v200, v200, v206, -v207
    v_fma_f32 v201, v201, v206, -v207
    v_exp_f32 v198, v198
    v_exp_f32 v199, v199
    v_exp_f32 v200, v200
    v_exp_f32 v201, v201
    v_cvt_pk_bf16_f32 v198, v198, v199
    v_cvt_pk_bf16_f32 v199, v200, v201
    v_and_b32 v210, v248, v198
    v_and_b32 v211, v249, v199
    v_and_b32 v212, v250, v198
    v_and_b32 v213, v251, v199
    v_mfma_f32_16x16x16_bf16 v[202:205], v[20:21], v[198:199], 0
    s_nop 0
    v_mfma_f32_16x16x32_bf16 v[180:183], v[94:97], v[210:213], 0
    s_nop 5
    v_rcp_f32 v202, v202
    s_nop 0
    v_mul_f32 v180, v180, v202
    v_mul_f32 v181, v181, v202
    v_mul_f32 v182, v182, v202
    v_mul_f32 v183, v183, v202
    v_cvt_pk_bf16_f32 v178, v180, v181
    v_cvt_pk_bf16_f32 v179, v182, v183
    s_add_u32 s53, s85, 65536
    s_mov_b64 exec, s[28:29]
    buffer_store_dwordx2 v[178:179], v13, s[44:47], s53 offen
    s_mov_b64 exec, s[16:17]
    buffer_store_dwordx2 v[178:179], v13, s[44:47], s53 offen  sc1
    s_mov_b64 exec, -1
    s_mov_b32 s92, 1
    v_mov_b32 v240, s90
    v_mov_b32 v241, s65
    s_waitcnt vmcnt(0)
    s_mov_b64 exec, s[28:29]
    buffer_store_dword v240, v241, s[44:47], s84 offen
    s_mov_b64 exec, s[16:17]
    buffer_store_dword v240, v241, s[44:47], s84 offen sc1
    s_mov_b64 exec, -1
    v_cmp_ne_u32 vcc, s90, v75
    v_cmp_ne_u32 s[96:97], s90, v77
    s_nop 0
    s_or_b64 vcc, vcc, s[96:97]
    s_cmp_eq_u64 vcc, 0
    s_nop 0
    s_cbranch_scc1 Lwin_16
    s_mov_b32 s95, 0x200000
Lp_17:
    buffer_load_dwordx4 v[74:77], v86, s[44:47], s11 offen sc1
    s_waitcnt vmcnt(0)
    v_cmp_ne_u32 vcc, s90, v75
    v_cmp_ne_u32 s[96:97], s90, v77
    s_nop 0
    s_or_b64 vcc, vcc, s[96:97]
    s_cmp_eq_u64 vcc, 0
    s_nop 0
    s_cbranch_scc1 Ld_18
    s_sleep 2
    s_sub_u32 s95, s95, 1
    s_cmp_lg_u32 s95, 0
    s_cbranch_scc1 Lp_17
    s_branch L_abort
Ld_18:
Lwin_16:
    v_readfirstlane_b32 s8, v74
    v_readfirstlane_b32 s9, v76
    s_and_b32 s8, s8, 0x7ff
    s_and_b32 s9, s9, 0x7ff
    s_nop 1
    s_branch L_wo
L_final:
    v_add_f32 v166, v166, v170
    v_pk_add_f32 v[164:165], v[164:165], v[168:169]
    v_add_f32 v174, v174, v178
    v_pk_add_f32 v[172:173], v[172:173], v[176:177]
    v_add_f32 v166, v166, v174
    v_pk_add_f32 v[164:165], v[164:165], v[172:173]
    s_nop 0
    v_add_f32_dpp v166, v166, v166 quad_perm:[1,0,3,2] row_mask:0xf bank_mask:0xf
    v_add_f32_dpp v164, v164, v164 quad_perm:[1,0,3,2] row_mask:0xf bank_mask:0xf
    v_add_f32_dpp v165, v165, v165 quad_perm:[1,0,3,2] row_mask:0xf bank_mask:0xf
    v_mul_f32 v180, 0x3b000000, v164
    v_mul_f32 v181, 0x3b000000, v166
    v_fma_f32 v181, -v180, v180, v181
    v_max_f32 v181, 0, v181
    v_cvt_pk_bf16_f32 v190, v181, v181
    v_lshlrev_b32 v190, 16, v190
    v_add_f32 v190, 0x3727c5ac, v190
    v_cvt_pk_bf16_f32 v190, v190, v190
    v_lshlrev_b32 v190, 16, v190
    v_sqrt_f32 v190, v190
    v_cvt_pk_bf16_f32 v189, v180, v180
    v_cvt_pk_bf16_f32 v190, v190, v190
    v_lshlrev_b32 v190, 16, v190
    v_rcp_f32 v190, v190
    v_lshlrev_b32 v189, 16, v189
    v_fma_f32 v184, -v189, s93, v165
    v_add_f32 v182, 1.0, v190
    v_mul_f32 v184, v184, v190
    v_mul_f32 v183, -v189, v190
    v_ashrrev_i32 v188, 31, v184
    ds_write_b32 v161, v182 offset:768
    v_or_b32 v188, 0x80000000, v188
    ds_write_b32 v161, v183 offset:1152
    v_xor_b32 v188, v188, v184
    v_and_or_b32 v188, v188, s18, v162
    v_cndmask_b32 v188, 0, v188, s[98:99]
    ds_write_b32 v161, v188 offset:1536
    s_waitcnt lgkmcnt(0)
    s_barrier
    ds_read_b32 v164, v163
    ds_read_b32 v165, v252 offset:1792
    s_waitcnt lgkmcnt(0)
    v_max_u32 v186, v164, v165
    s_nop 1
    v_max_u32_dpp v186, v186, v186 quad_perm:[1,0,3,2] row_mask:0xf bank_mask:0xf
    s_nop 1
    v_max_u32_dpp v186, v186, v186 quad_perm:[2,3,0,1] row_mask:0xf bank_mask:0xf
    s_nop 1
    v_max_u32_dpp v186, v186, v186 row_half_mirror row_mask:0xf bank_mask:0xf
    s_nop 1
    v_max_u32_dpp v186, v186, v186 row_mirror row_mask:0xf bank_mask:0xf
    s_nop 1
    v_max_u32_dpp v186, v186, v186 row_bcast:15 row_mask:0xa bank_mask:0xf
    s_nop 1
    v_max_u32_dpp v186, v186, v186 row_bcast:31 row_mask:0xc bank_mask:0xf
    s_nop 0
    v_readlane_b32 s70, v186, 63
    s_nop 1
    v_cmp_ne_u32 vcc, s70, v164
    s_nop 1
    v_cndmask_b32 v186, 0, v164, vcc
    v_cmp_ne_u32 vcc, s70, v165
    s_nop 1
    v_cndmask_b32 v187, 0, v165, vcc
    v_max_u32 v186, v186, v187
    s_nop 1
    v_max_u32_dpp v186, v186, v186 quad_perm:[1,0,3,2] row_mask:0xf bank_mask:0xf
    s_nop 1
    v_max_u32_dpp v186, v186, v186 quad_perm:[2,3,0,1] row_mask:0xf bank_mask:0xf
    s_nop 1
    v_max_u32_dpp v186, v186, v186 row_half_mirror row_mask:0xf bank_mask:0xf
    s_nop 1
    v_max_u32_dpp v186, v186, v186 row_mirror row_mask:0xf bank_mask:0xf
    s_nop 1
    v_max_u32_dpp v186, v186, v186 row_bcast:15 row_mask:0xa bank_mask:0xf
    s_nop 1
    v_max_u32_dpp v186, v186, v186 row_bcast:31 row_mask:0xc bank_mask:0xf
    s_nop 0
    v_readlane_b32 s71, v186, 63
    s_nop 1
    v_cmp_eq_u32 vcc, s71, v188
    v_cmp_eq_u32 s[96:97], s70, v188
    s_nop 0
    v_cndmask_b32 v186, 0, 16, vcc
    s_or_b64 vcc, vcc, s[96:97]
    s_and_b64 exec, vcc, s[100:101]
    buffer_store_dwordx4 v[188:191], v186, s[44:47], s15 offen sc1
    s_mov_b64 exec, -1
    s_bfe_u32 s74, s70, 0xa0001
    s_sub_u32 s74, s74, s31
    s_lshr_b32 s54, s74, 4
    s_lshl_b32 s54, s54, 1
    s_and_b32 s53, s74, 15
    s_set_gpr_idx_on s54, gpr_idx(SRC0)
    v_mov_b32 v192, v72
    v_mov_b32 v194, v73
    s_set_gpr_idx_off
    v_cmp_eq_u32 vcc, s53, v3
    s_nop 0
    s_mov_b64 exec, vcc
    buffer_store_dwordx4 v[192:195], v185, s[44:47], s14 offen offset:0 sc1
    s_mov_b64 exec, -1
    s_bfe_u32 s75, s71, 0xa0001
    s_sub_u32 s75, s75, s31
    s_lshr_b32 s54, s75, 4
    s_lshl_b32 s54, s54, 1
    s_and_b32 s53, s75, 15
    s_set_gpr_idx_on s54, gpr_idx(SRC0)
    v_mov_b32 v196, v72
    v_mov_b32 v198, v73
    s_set_gpr_idx_off
    v_cmp_eq_u32 vcc, s53, v3
    s_nop 0
    s_mov_b64 exec, vcc
    buffer_store_dwordx4 v[196:199], v185, s[44:47], s14 offen offset:2048 sc1
    s_mov_b64 exec, -1
    ds_read_b32 v170, v252 offset:768
    ds_read_b32 v171, v252 offset:1152
    ds_read_b32 v172, v252 offset:832
    ds_read_b32 v173, v252 offset:1216
    ds_read_b32 v174, v252 offset:896
    ds_read_b32 v175, v252 offset:1280
    ds_read_b32 v176, v252 offset:960
    ds_read_b32 v177, v252 offset:1344
    ds_read_b32 v178, v252 offset:1024
    ds_read_b32 v179, v252 offset:1408
    s_waitcnt lgkmcnt(8)
    v_pk_fma_f32 v[52:53], v[140:141], v[170:171], v[170:171] op_sel:[0,0,1] op_sel_hi:[1,0,1]
    v_pk_fma_f32 v[54:55], v[142:143], v[170:171], v[170:171] op_sel:[0,0,1] op_sel_hi:[1,0,1]
    s_waitcnt lgkmcnt(6)
    v_pk_fma_f32 v[56:57], v[144:145], v[172:173], v[172:173] op_sel:[0,0,1] op_sel_hi:[1,0,1]
    v_pk_fma_f32 v[58:59], v[146:147], v[172:173], v[172:173] op_sel:[0,0,1] op_sel_hi:[1,0,1]
    s_waitcnt lgkmcnt(4)
    v_pk_fma_f32 v[60:61], v[148:149], v[174:175], v[174:175] op_sel:[0,0,1] op_sel_hi:[1,0,1]
    v_pk_fma_f32 v[62:63], v[150:151], v[174:175], v[174:175] op_sel:[0,0,1] op_sel_hi:[1,0,1]
    s_waitcnt lgkmcnt(2)
    v_pk_fma_f32 v[64:65], v[152:153], v[176:177], v[176:177] op_sel:[0,0,1] op_sel_hi:[1,0,1]
    v_pk_fma_f32 v[66:67], v[154:155], v[176:177], v[176:177] op_sel:[0,0,1] op_sel_hi:[1,0,1]
    s_waitcnt lgkmcnt(0)
    v_pk_fma_f32 v[68:69], v[156:157], v[178:179], v[178:179] op_sel:[0,0,1] op_sel_hi:[1,0,1]
    v_pk_fma_f32 v[70:71], v[158:159], v[178:179], v[178:179] op_sel:[0,0,1] op_sel_hi:[1,0,1]
    v_cvt_pk_bf16_f32 v72, v52, v53
    v_cvt_pk_bf16_f32 v73, v54, v55
    v_cvt_pk_bf16_f32 v74, v56, v57
    v_cvt_pk_bf16_f32 v75, v58, v59
    v_cvt_pk_bf16_f32 v76, v60, v61
    v_cvt_pk_bf16_f32 v77, v62, v63
    v_cvt_pk_bf16_f32 v78, v64, v65
    v_cvt_pk_bf16_f32 v79, v66, v67
    v_cvt_pk_bf16_f32 v80, v68, v69
    v_cvt_pk_bf16_f32 v81, v70, v71
    s_and_b32 s76, s70, 0x7ff
    s_and_b32 s77, s71, 0x7ff
    s_cmp_lg_u32 s68, 0
    s_cselect_b32 s53, 7, 0
    s_movk_i32 s54, 2048
    v_add_u32 v164, 0, v17
    v_cmp_ne_u32 vcc, s76, v164
    v_cmp_ne_u32 s[96:97], s77, v164
    s_nop 0
    s_and_b64 vcc, vcc, s[96:97]
    v_subrev_u32 v165, s8, v164
    v_and_b32 v165, 0xfffffff1, v165
    v_cmp_ne_u32 s[96:97], 0, v165
    s_nop 0
    s_and_b64 vcc, vcc, s[96:97]
    v_subrev_u32 v165, s9, v164
    v_and_b32 v165, 0xfffffff1, v165
    v_cmp_ne_u32 s[96:97], 0, v165
    s_nop 0
    s_and_b64 vcc, vcc, s[96:97]
    v_cmp_le_u32 s[96:97], s53, v3
    s_nop 0
    s_and_b64 vcc, vcc, s[96:97]
    s_add_u32 s52, s69, 0
    s_mov_b64 exec, vcc
    buffer_store_dwordx2 v[72:73], v18, s[48:51], s52 offen
    s_mov_b64 exec, -1
    v_add_u32 v164, 32, v17
    v_cmp_ne_u32 vcc, s76, v164
    v_cmp_ne_u32 s[96:97], s77, v164
    s_nop 0
    s_and_b64 vcc, vcc, s[96:97]
    v_subrev_u32 v165, s8, v164
    v_and_b32 v165, 0xfffffff1, v165
    v_cmp_ne_u32 s[96:97], 0, v165
    s_nop 0
    s_and_b64 vcc, vcc, s[96:97]
    v_subrev_u32 v165, s9, v164
    v_and_b32 v165, 0xfffffff1, v165
    v_cmp_ne_u32 s[96:97], 0, v165
    s_nop 0
    s_and_b64 vcc, vcc, s[96:97]
    s_add_u32 s52, s69, 32768
    s_mov_b64 exec, vcc
    buffer_store_dwordx2 v[74:75], v18, s[48:51], s52 offen
    s_mov_b64 exec, -1
    v_add_u32 v164, 64, v17
    v_cmp_ne_u32 vcc, s76, v164
    v_cmp_ne_u32 s[96:97], s77, v164
    s_nop 0
    s_and_b64 vcc, vcc, s[96:97]
    v_subrev_u32 v165, s8, v164
    v_and_b32 v165, 0xfffffff1, v165
    v_cmp_ne_u32 s[96:97], 0, v165
    s_nop 0
    s_and_b64 vcc, vcc, s[96:97]
    v_subrev_u32 v165, s9, v164
    v_and_b32 v165, 0xfffffff1, v165
    v_cmp_ne_u32 s[96:97], 0, v165
    s_nop 0
    s_and_b64 vcc, vcc, s[96:97]
    s_add_u32 s52, s69, 65536
    s_mov_b64 exec, vcc
    buffer_store_dwordx2 v[76:77], v18, s[48:51], s52 offen
    s_mov_b64 exec, -1
    v_add_u32 v164, 96, v17
    v_cmp_ne_u32 vcc, s76, v164
    v_cmp_ne_u32 s[96:97], s77, v164
    s_nop 0
    s_and_b64 vcc, vcc, s[96:97]
    v_subrev_u32 v165, s8, v164
    v_and_b32 v165, 0xfffffff1, v165
    v_cmp_ne_u32 s[96:97], 0, v165
    s_nop 0
    s_and_b64 vcc, vcc, s[96:97]
    v_subrev_u32 v165, s9, v164
    v_and_b32 v165, 0xfffffff1, v165
    v_cmp_ne_u32 s[96:97], 0, v165
    s_nop 0
    s_and_b64 vcc, vcc, s[96:97]
    s_add_u32 s52, s69, 98304
    s_mov_b64 exec, vcc
    buffer_store_dwordx2 v[78:79], v18, s[48:51], s52 offen
    s_mov_b64 exec, -1
    v_add_u32 v164, 128, v17
    v_cmp_ne_u32 vcc, s76, v164
    v_cmp_ne_u32 s[96:97], s77, v164
    s_nop 0
    s_and_b64 vcc, vcc, s[96:97]
    v_subrev_u32 v165, s8, v164
    v_and_b32 v165, 0xfffffff1, v165
    v_cmp_ne_u32 s[96:97], 0, v165
    s_nop 0
    s_and_b64 vcc, vcc, s[96:97]
    v_subrev_u32 v165, s9, v164
    v_and_b32 v165, 0xfffffff1, v165
    v_cmp_ne_u32 s[96:97], 0, v165
    s_nop 0
    s_and_b64 vcc, vcc, s[96:97]
    v_cmp_gt_u32 s[96:97], s54, v164
    s_nop 0
    s_and_b64 vcc, vcc, s[96:97]
    s_add_u32 s52, s69, 131072
    s_mov_b64 exec, vcc
    buffer_store_dwordx2 v[80:81], v18, s[48:51], s52 offen
    s_mov_b64 exec, -1
    s_lshr_b32 s54, s74, 4
    s_lshl_b32 s54, s54, 1
    s_set_gpr_idx_on s54, gpr_idx(SRC0)
    v_mov_b32 v168, v72
    v_mov_b32 v169, v73
    s_set_gpr_idx_off
    s_lshr_b32 s54, s75, 4
    s_lshl_b32 s54, s54, 1
    s_set_gpr_idx_on s54, gpr_idx(SRC0)
    v_mov_b32 v170, v72
    v_mov_b32 v171, v73
    s_set_gpr_idx_off
    s_add_u32 s52, s72, 174976
    s_mov_b32 s95, 0x200000
Lp_19:
    buffer_load_dwordx4 v[160:163], v86, s[44:47], s52 offen sc1
    s_waitcnt vmcnt(0)
    v_cmp_ne_u32 vcc, s90, v161
    v_cmp_ne_u32 s[96:97], s90, v163
    s_nop 0
    s_or_b64 vcc, vcc, s[96:97]
    s_cmp_eq_u64 vcc, 0
    s_nop 0
    s_cbranch_scc1 Ld_20
    s_sleep 4
    s_sub_u32 s95, s95, 1
    s_cmp_lg_u32 s95, 0
    s_cbranch_scc1 Lp_19
    s_branch L_abort
Ld_20:
    s_and_b32 s53, s74, 15
    s_lshl_b32 s52, s76, 10
    v_cmp_eq_u32 vcc, s53, v3
    v_cmp_ne_u32 s[96:97], s70, v160
    s_nop 0
    s_and_b64 vcc, vcc, s[96:97]
    v_cmp_ne_u32 s[96:97], s70, v162
    s_nop 0
    s_and_b64 exec, vcc, s[96:97]
    buffer_store_dwordx2 v[168:169], v14, s[48:51], s52 offen
    s_mov_b64 exec, -1
    s_and_b32 s53, s75, 15
    s_lshl_b32 s52, s77, 10
    v_cmp_eq_u32 vcc, s53, v3
    v_cmp_ne_u32 s[96:97], s71, v160
    s_nop 0
    s_and_b64 vcc, vcc, s[96:97]
    v_cmp_ne_u32 s[96:97], s71, v162
    s_nop 0
    s_and_b64 exec, vcc, s[96:97]
    buffer_store_dwordx2 v[170:171], v14, s[48:51], s52 offen
    s_mov_b64 exec, -1
    s_branch L_fin
L_F:
    v_lshrrev_b32 v8, 3, v1
    s_lshl_b32 s53, s3, 3
    v_add_u32 v9, s53, v8
    v_bfe_u32 v14, v9, 1, 1
    v_bfe_u32 v11, v9, 3, 1
    v_lshl_add_u32 v14, v11, 1, v14
    v_bfe_u32 v11, v1, 1, 2
    v_sub_u32 v11, v11, v14
    v_and_b32 v11, 3, v11
    v_and_b32 v13, 1, v1
    v_lshlrev_b32 v13, 4, v13
    v_lshl_add_u32 v13, v11, 5, v13
    s_getreg_b32 s81, hwreg(HW_REG_XCC_ID)
    s_and_b32 s81, s81, 15
    s_min_u32 s55, s5, 27
    v_mul_u32_u24 v160, 3584, v9
    v_add_u32 v160, v160, v13
    v_lshrrev_b32 v161, 1, v1
    v_and_b32 v162, 0x13, v161
    v_bfe_u32 v163, v161, 2, 1
    v_lshl_or_b32 v162, v163, 3, v162
    v_bfe_u32 v163, v161, 3, 1
    v_lshl_or_b32 v162, v163, 2, v162
    v_and_b32 v163, 1, v1
    v_lshlrev_b32 v163, 4, v163
    v_mul_u32_u24 v161, 3072, v162
    v_add_u32 v161, v161, v163
    v_lshl_add_u32 v162, v162, 10, v163
    s_lshl_b32 s74, s55, 7
    s_lshl_b32 s75, s3, 10
    s_lshl_b32 s76, s3, 14
    s_add_u32 s76, s76, 65536
    s_lshl_b32 s54, s5, 5
    s_mul_i32 s53, s3, 393216
    s_add_u32 s53, s53, s54
    s_lshl_b32 s77, s3, 17
    s_add_u32 s77, s77, s54
    s_waitcnt lgkmcnt(0)
    s_load_dword s94, s[28:29], 0
    s_mov_b32 s36, s10
    s_and_b32 s37, s11, 0xffff
    s_mov_b32 s38, 1572864
    s_mov_b32 s39, 0x00020000
    s_mov_b32 s40, s12
    s_and_b32 s41, s13, 0xffff
    s_mov_b32 s42, 524288
    s_mov_b32 s43, 0x00020000
    s_cmp_ge_u32 s5, 24
    s_cbranch_scc1 L_cwo
    v_mul_u32_u24 v164, 3072, v9
    v_add_u32 v164, v164, v13
    s_lshl_b32 s52, s5, 1
    s_add_u32 s52, s52, 0
    s_mul_i32 s96, s52, 0x5556
    s_lshr_b32 s96, s96, 16
    s_mul_i32 s97, s96, 3
    s_sub_u32 s97, s52, s97
    s_lshl_b32 s97, s97, 10
    s_mul_i32 s52, s96, 98304
    s_add_u32 s52, s52, s97
    s_add_u32 s52, s52, 384
    buffer_load_dwordx4 v[96:99], v164, s[36:39], s52 offen
    s_mul_i32 s96, s96, 12288
    s_add_u32 s96, s96, s97
    s_mul_i32 s97, s3, 3072
    s_add_u32 s98, s96, s97
    s_lshl_b32 s52, s5, 1
    s_add_u32 s52, s52, 1
    s_mul_i32 s96, s52, 0x5556
    s_lshr_b32 s96, s96, 16
    s_mul_i32 s97, s96, 3
    s_sub_u32 s97, s52, s97
    s_lshl_b32 s97, s97, 10
    s_mul_i32 s52, s96, 98304
    s_add_u32 s52, s52, s97
    s_add_u32 s52, s52, 384
    buffer_load_dwordx4 v[100:103], v164, s[36:39], s52 offen
    s_mul_i32 s96, s96, 12288
    s_add_u32 s96, s96, s97
    s_mul_i32 s97, s3, 3072
    s_add_u32 s99, s96, s97
    s_branch L_cw2
L_cwo:
    v_lshl_add_u32 v164, v9, 10, v13
    s_lshl_b32 s52, s5, 1
    s_sub_u32 s96, s52, 48
    s_lshl_b32 s52, s96, 15
    s_add_u32 s52, s52, 384
    buffer_load_dwordx4 v[96:99], v164, s[40:43], s52 offen
    s_lshl_b32 s96, s96, 12
    s_add_u32 s96, s96, s75
    s_add_u32 s98, s96, 196608
    s_lshl_b32 s52, s5, 1
    s_sub_u32 s96, s52, 47
    s_lshl_b32 s52, s96, 15
    s_add_u32 s52, s52, 384
    buffer_load_dwordx4 v[100:103], v164, s[40:43], s52 offen
    s_lshl_b32 s96, s96, 12
    s_add_u32 s96, s96, s75
    s_add_u32 s99, s96, 196608
L_cw2:
    s_mov_b32 s44, s28
    s_and_b32 s45, s29, 0xffff
    s_mov_b32 s46, 268435456
    s_mov_b32 s47, 0x00020000
    s_mov_b32 s56, s18
    s_and_b32 s57, s19, 0xffff
    s_mov_b32 s58, 1835008
    s_mov_b32 s59, 0x00020000
    s_mov_b32 s60, s20
    s_and_b32 s61, s21, 0xffff
    s_mov_b32 s62, 1835008
    s_mov_b32 s63, 0x00020000
    s_mov_b32 s64, s22
    s_and_b32 s65, s23, 0xffff
    s_mov_b32 s66, 1835008
    s_mov_b32 s67, 0x00020000
    s_mov_b32 s48, s24
    s_and_b32 s49, s25, 0xffff
    s_mov_b32 s50, 2097152
    s_mov_b32 s51, 0x00020000
    v_lshlrev_b32 v164, 3, v2
    v_add_u32 v164, s54, v164
    v_lshlrev_b32 v165, 4, v1
    s_add_u32 s98, s98, 851968
    s_add_u32 s99, s99, 851968
    s_lshl_b32 s100, s5, 4
    s_lshl_b32 s96, s3, 2
    s_add_u32 s100, s100, s96
    s_add_u32 s100, s100, 1146880
    s_waitcnt vmcnt(0) lgkmcnt(0)
    buffer_store_dwordx4 v[96:99], v165, s[44:47], s98 offen sc1
    buffer_store_dwordx4 v[100:103], v165, s[44:47], s99 offen sc1
    s_mul_i32 s90, s94, 0x9e3779b1
    s_add_u32 s90, s90, 0x7f4a7c15
    v_mov_b32 v104, s90
    v_mov_b32 v105, 0
    v_mov_b32 v180, s81
    v_mov_b32 v181, s90
    s_lshl_b32 s52, s5, 7
    s_add_u32 s52, s52, 1208320
    s_waitcnt vmcnt(0)
    s_mov_b64 exec, 1
    buffer_store_dword v104, v105, s[44:47], s100 offen sc1
    s_cmp_eq_u32 s3, 0
    s_cselect_b64 exec, 1, 0
    buffer_store_dwordx2 v[180:181], v105, s[44:47], s52 offen sc1
    s_mov_b64 exec, -1
    s_add_u32 m0, s75, 0
    s_add_u32 s52, s74, 0
    buffer_load_dwordx4 v160, s[56:59], s52 offen lds
    s_add_u32 m0, s75, 4096
    s_add_u32 s52, s74, 114688
    buffer_load_dwordx4 v160, s[56:59], s52 offen lds
    s_add_u32 m0, s75, 8192
    s_add_u32 s52, s74, 229376
    buffer_load_dwordx4 v160, s[56:59], s52 offen lds
    s_add_u32 m0, s75, 12288
    s_add_u32 s52, s74, 344064
    buffer_load_dwordx4 v160, s[56:59], s52 offen lds
    s_add_u32 m0, s75, 16384
    s_add_u32 s52, s74, 458752
    buffer_load_dwordx4 v160, s[56:59], s52 offen lds
    s_add_u32 m0, s75, 20480
    s_add_u32 s52, s74, 573440
    buffer_load_dwordx4 v160, s[56:59], s52 offen lds
    s_add_u32 m0, s75, 24576
    s_add_u32 s52, s74, 688128
    buffer_load_dwordx4 v160, s[56:59], s52 offen lds
    s_add_u32 m0, s75, 28672
    s_add_u32 s52, s74, 802816
    buffer_load_dwordx4 v160, s[56:59], s52 offen lds
    s_add_u32 m0, s75, 32768
    s_add_u32 s52, s74, 917504
    buffer_load_dwordx4 v160, s[56:59], s52 offen lds
    s_add_u32 m0, s75, 36864
    s_add_u32 s52, s74, 1032192
    buffer_load_dwordx4 v160, s[56:59], s52 offen lds
    s_add_u32 m0, s75, 40960
    s_add_u32 s52, s74, 1146880
    buffer_load_dwordx4 v160, s[56:59], s52 offen lds
    s_add_u32 m0, s75, 45056
    s_add_u32 s52, s74, 1261568
    buffer_load_dwordx4 v160, s[56:59], s52 offen lds
    s_add_u32 m0, s75, 49152
    s_add_u32 s52, s74, 1376256
    buffer_load_dwordx4 v160, s[56:59], s52 offen lds
    s_add_u32 m0, s75, 53248
    s_add_u32 s52, s74, 1490944
    buffer_load_dwordx4 v160, s[56:59], s52 offen lds
    s_add_u32 m0, s75, 57344
    s_add_u32 s52, s74, 1605632
    buffer_load_dwordx4 v160, s[56:59], s52 offen lds
    s_add_u32 m0, s75, 61440
    s_add_u32 s52, s74, 1720320
    buffer_load_dwordx4 v160, s[56:59], s52 offen lds
    s_add_u32 m0, s75, 65536
    s_add_u32 s52, s74, 0
    buffer_load_dwordx4 v160, s[60:63], s52 offen lds
    s_add_u32 m0, s75, 69632
    s_add_u32 s52, s74, 114688
    buffer_load_dwordx4 v160, s[60:63], s52 offen lds
    s_add_u32 m0, s75, 73728
    s_add_u32 s52, s74, 229376
    buffer_load_dwordx4 v160, s[60:63], s52 offen lds
    s_add_u32 m0, s75, 77824
    s_add_u32 s52, s74, 344064
    buffer_load_dwordx4 v160, s[60:63], s52 offen lds
    s_add_u32 m0, s75, 81920
    s_add_u32 s52, s74, 458752
    buffer_load_dwordx4 v160, s[60:63], s52 offen lds
    s_add_u32 m0, s75, 86016
    s_add_u32 s52, s74, 573440
    buffer_load_dwordx4 v160, s[60:63], s52 offen lds
    s_add_u32 m0, s75, 90112
    s_add_u32 s52, s74, 688128
    buffer_load_dwordx4 v160, s[60:63], s52 offen lds
    s_add_u32 m0, s75, 94208
    s_add_u32 s52, s74, 802816
    buffer_load_dwordx4 v160, s[60:63], s52 offen lds
    s_add_u32 m0, s75, 98304
    s_add_u32 s52, s74, 917504
    buffer_load_dwordx4 v160, s[60:63], s52 offen lds
    s_add_u32 m0, s75, 102400
    s_add_u32 s52, s74, 1032192
    buffer_load_dwordx4 v160, s[60:63], s52 offen lds
    s_add_u32 m0, s75, 106496
    s_add_u32 s52, s74, 1146880
    buffer_load_dwordx4 v160, s[60:63], s52 offen lds
    s_add_u32 m0, s75, 110592
    s_add_u32 s52, s74, 1261568
    buffer_load_dwordx4 v160, s[60:63], s52 offen lds
    s_add_u32 m0, s75, 114688
    s_add_u32 s52, s74, 1376256
    buffer_load_dwordx4 v160, s[60:63], s52 offen lds
    s_add_u32 m0, s75, 118784
    s_add_u32 s52, s74, 1490944
    buffer_load_dwordx4 v160, s[60:63], s52 offen lds
    s_add_u32 m0, s75, 122880
    s_add_u32 s52, s74, 1605632
    buffer_load_dwordx4 v160, s[60:63], s52 offen lds
    s_add_u32 m0, s75, 126976
    s_add_u32 s52, s74, 1720320
    buffer_load_dwordx4 v160, s[60:63], s52 offen lds
    global_load_dwordx2 v[48:49], v164, s[16:17]
    global_load_dwordx4 v[176:179], v165, s[16:17]
    v_lshlrev_b32 v190, 7, v1
    s_lshl_b32 s52, s55, 13
    s_and_b32 s96, s3, 1
    s_mul_i32 s96, s96, 262144
    s_add_u32 s52, s52, s96
    s_add_u32 s52, s52, 196608
    s_mul_i32 s96, s5, 4864
    s_add_u32 s96, s96, 4096
    s_cmp_ge_u32 s3, 2
    s_cselect_b32 s52, s96, s52
    buffer_load_dword v254, v190, s[44:47], s52 offen sc1
    v_min_u32 v190, 27, v1
    s_mov_b32 s52, 267776
    v_mul_lo_u32 v190, v190, s52
    s_mov_b32 s52, 2272256
    buffer_load_dword v254, v190, s[44:47], s52 offen sc1
    s_mov_b32 s78, 0x3f803f80
    s_mov_b32 s79, 1052289595
    v_mov_b32 v20, s78
    v_mov_b32 v21, s78
    v_mov_b32 v22, s78
    v_mov_b32 v23, s78
    v_lshrrev_b32 v166, 1, v2
    v_lshlrev_b32 v166, 4, v166
    v_and_b32 v167, 1, v2
    v_lshl_add_u32 v166, v167, 2, v166
    v_bfe_u32 v167, v1, 2, 2
    v_add_u32 v166, v166, v167
    v_lshlrev_b32 v166, 5, v166
    v_and_b32 v167, 3, v1
    v_lshl_add_u32 v166, v167, 3, v166
    v_add_u32 v166, s76, v166
    s_mul_i32 s52, s3, 3072
    s_add_u32 s52, s52, 131072
    v_add_u32 v182, s52, v165
    v_add_u32 v183, 131072, v165
    v_bfe_u32 v170, v1, 2, 2
    v_lshrrev_b32 v171, 1, v170
    v_and_b32 v172, 1, v2
    v_lshl_add_u32 v171, v172, 1, v171
    v_add_u32 v171, s3, v171
    v_and_b32 v171, 3, v171
    v_lshlrev_b32 v170, 7, v170
    v_lshl_add_u32 v170, v171, 5, v170
    v_and_b32 v172, 3, v1
    v_lshl_add_u32 v170, v172, 3, v170
    v_mul_u32_u24 v82, 1024, v2
    v_add_u32 v82, v82, v170
    v_add_u32 v19, 65536, v82
    s_and_b32 s96, s3, 1
    s_lshl_b32 s96, s96, 7
    s_add_u32 s52, s96, 0
    v_xor_b32 v172, s52, v165
    s_add_u32 s52, s96, 32
    v_xor_b32 v173, s52, v165
    s_add_u32 s52, s96, 64
    v_xor_b32 v174, s52, v165
    s_add_u32 s52, s96, 96
    v_xor_b32 v175, s52, v165
    s_lshl_b32 s74, s55, 16
    s_lshl_b32 s75, s3, 13
    s_add_u32 s74, s74, s75
    s_lshl_b32 s52, s3, 8
    v_add_u32 v167, 0, v2
    v_xor_b32 v167, v167, v3
    v_lshlrev_b32 v167, 4, v167
    v_lshl_add_u32 v66, v3, 10, v167
    v_add_u32 v66, s52, v66
    v_add_u32 v167, 4, v2
    v_xor_b32 v167, v167, v3
    v_lshlrev_b32 v167, 4, v167
    v_lshl_add_u32 v67, v3, 10, v167
    v_add_u32 v67, s52, v67
    v_add_u32 v167, 8, v2
    v_xor_b32 v167, v167, v3
    v_lshlrev_b32 v167, 4, v167
    v_lshl_add_u32 v68, v3, 10, v167
    v_add_u32 v68, s52, v68
    v_add_u32 v167, 12, v2
    v_xor_b32 v167, v167, v3
    v_lshlrev_b32 v167, 4, v167
    v_lshl_add_u32 v69, v3, 10, v167
    v_add_u32 v69, s52, v69
    v_mov_b32 v32, 4284592614
    v_lshl_add_u32 v167, v2, 2, 0
    v_sub_u32 v167, v3, v167
    v_cmp_gt_u32 vcc, 8, v167
    s_nop 1
    v_cndmask_b32 v24, v32, 0, vcc
    v_lshl_add_u32 v167, v2, 2, 1
    v_sub_u32 v167, v3, v167
    v_cmp_gt_u32 vcc, 8, v167
    s_nop 1
    v_cndmask_b32 v25, v32, 0, vcc
    v_lshl_add_u32 v167, v2, 2, 2
    v_sub_u32 v167, v3, v167
    v_cmp_gt_u32 vcc, 8, v167
    s_nop 1
    v_cndmask_b32 v26, v32, 0, vcc
    v_lshl_add_u32 v167, v2, 2, 3
    v_sub_u32 v167, v3, v167
    v_cmp_gt_u32 vcc, 8, v167
    s_nop 1
    v_cndmask_b32 v27, v32, 0, vcc
    v_bfe_u32 v168, v1, 2, 2
    v_lshl_add_u32 v167, v2, 3, v168
    v_lshlrev_b32 v167, 10, v167
    v_and_b32 v169, 1, v2
    v_lshl_add_u32 v169, v169, 2, v168
    v_lshl_add_u32 v167, v169, 5, v167
    v_and_b32 v169, 3, v1
    v_lshl_add_u32 v167, v169, 3, v167
    v_add_u32 v167, s52, v167
    v_mov_b32 v74, 0
    s_waitcnt vmcnt(20)
    s_barrier
    ds_read_b64_tr_b16 a[0:1], v82 offset:0
    ds_read_b64_tr_b16 a[2:3], v82 offset:512
    ds_read_b64_tr_b16 a[8:9], v82 offset:4096
    ds_read_b64_tr_b16 a[10:11], v82 offset:4608
    ds_read_b64_tr_b16 a[16:17], v82 offset:8192
    ds_read_b64_tr_b16 a[18:19], v82 offset:8704
    ds_read_b64_tr_b16 a[24:25], v82 offset:12288
    ds_read_b64_tr_b16 a[26:27], v82 offset:12800
    ds_read_b64_tr_b16 a[32:33], v82 offset:16384
    ds_read_b64_tr_b16 a[34:35], v82 offset:16896
    ds_read_b64_tr_b16 a[40:41], v82 offset:20480
    ds_read_b64_tr_b16 a[42:43], v82 offset:20992
    ds_read_b64_tr_b16 a[48:49], v82 offset:24576
    ds_read_b64_tr_b16 a[50:51], v82 offset:25088
    ds_read_b64_tr_b16 a[56:57], v82 offset:28672
    ds_read_b64_tr_b16 a[58:59], v82 offset:29184
    ds_read_b64_tr_b16 a[64:65], v82 offset:32768
    ds_read_b64_tr_b16 a[66:67], v82 offset:33280
    ds_read_b64_tr_b16 a[72:73], v82 offset:36864
    ds_read_b64_tr_b16 a[74:75], v82 offset:37376
    ds_read_b64_tr_b16 a[80:81], v82 offset:40960
    ds_read_b64_tr_b16 a[82:83], v82 offset:41472
    ds_read_b64_tr_b16 a[88:89], v82 offset:45056
    ds_read_b64_tr_b16 a[90:91], v82 offset:45568
    ds_read_b64_tr_b16 a[96:97], v82 offset:49152
    ds_read_b64_tr_b16 a[98:99], v82 offset:49664
    ds_read_b64_tr_b16 a[104:105], v82 offset:53248
    ds_read_b64_tr_b16 a[106:107], v82 offset:53760
    ds_read_b64_tr_b16 a[112:113], v82 offset:57344
    ds_read_b64_tr_b16 a[114:115], v82 offset:57856
    ds_read_b64_tr_b16 a[120:121], v82 offset:61440
    ds_read_b64_tr_b16 a[122:123], v82 offset:61952
    s_waitcnt lgkmcnt(0)
    s_barrier
    s_add_u32 m0, s75, 0
    s_add_u32 s52, s74, 0
    buffer_load_dwordx4 v172, s[64:67], s52 offen lds
    s_add_u32 m0, s75, 1024
    s_add_u32 s52, s74, 1024
    buffer_load_dwordx4 v173, s[64:67], s52 offen lds
    s_add_u32 m0, s75, 2048
    s_add_u32 s52, s74, 2048
    buffer_load_dwordx4 v174, s[64:67], s52 offen lds
    s_add_u32 m0, s75, 3072
    s_add_u32 s52, s74, 3072
    buffer_load_dwordx4 v175, s[64:67], s52 offen lds
    s_add_u32 m0, s75, 4096
    s_add_u32 s52, s74, 4096
    buffer_load_dwordx4 v172, s[64:67], s52 offen lds
    s_add_u32 m0, s75, 5120
    s_add_u32 s52, s74, 5120
    buffer_load_dwordx4 v173, s[64:67], s52 offen lds
    s_add_u32 m0, s75, 6144
    s_add_u32 s52, s74, 6144
    buffer_load_dwordx4 v174, s[64:67], s52 offen lds
    s_add_u32 m0, s75, 7168
    s_add_u32 s52, s74, 7168
    buffer_load_dwordx4 v175, s[64:67], s52 offen lds
    s_add_u32 m0, s75, 32768
    s_add_u32 s52, s74, 32768
    buffer_load_dwordx4 v172, s[64:67], s52 offen lds
    s_add_u32 m0, s75, 33792
    s_add_u32 s52, s74, 33792
    buffer_load_dwordx4 v173, s[64:67], s52 offen lds
    s_add_u32 m0, s75, 34816
    s_add_u32 s52, s74, 34816
    buffer_load_dwordx4 v174, s[64:67], s52 offen lds
    s_add_u32 m0, s75, 35840
    s_add_u32 s52, s74, 35840
    buffer_load_dwordx4 v175, s[64:67], s52 offen lds
    s_add_u32 m0, s75, 36864
    s_add_u32 s52, s74, 36864
    buffer_load_dwordx4 v172, s[64:67], s52 offen lds
    s_add_u32 m0, s75, 37888
    s_add_u32 s52, s74, 37888
    buffer_load_dwordx4 v173, s[64:67], s52 offen lds
    s_add_u32 m0, s75, 38912
    s_add_u32 s52, s74, 38912
    buffer_load_dwordx4 v174, s[64:67], s52 offen lds
    s_add_u32 m0, s75, 39936
    s_add_u32 s52, s74, 39936
    buffer_load_dwordx4 v175, s[64:67], s52 offen lds
    s_waitcnt vmcnt(16)
    s_barrier
    ds_read_b64_tr_b16 a[4:5], v19 offset:0
    ds_read_b64_tr_b16 a[6:7], v19 offset:512
    ds_read_b64_tr_b16 a[12:13], v19 offset:4096
    ds_read_b64_tr_b16 a[14:15], v19 offset:4608
    ds_read_b64_tr_b16 a[20:21], v19 offset:8192
    ds_read_b64_tr_b16 a[22:23], v19 offset:8704
    ds_read_b64_tr_b16 a[28:29], v19 offset:12288
    ds_read_b64_tr_b16 a[30:31], v19 offset:12800
    ds_read_b64_tr_b16 a[36:37], v19 offset:16384
    ds_read_b64_tr_b16 a[38:39], v19 offset:16896
    ds_read_b64_tr_b16 a[44:45], v19 offset:20480
    ds_read_b64_tr_b16 a[46:47], v19 offset:20992
    ds_read_b64_tr_b16 a[52:53], v19 offset:24576
    ds_read_b64_tr_b16 a[54:55], v19 offset:25088
    ds_read_b64_tr_b16 a[60:61], v19 offset:28672
    ds_read_b64_tr_b16 a[62:63], v19 offset:29184
    ds_read_b64_tr_b16 a[68:69], v19 offset:32768
    ds_read_b64_tr_b16 a[70:71], v19 offset:33280
    ds_read_b64_tr_b16 a[76:77], v19 offset:36864
    ds_read_b64_tr_b16 a[78:79], v19 offset:37376
    ds_read_b64_tr_b16 a[84:85], v19 offset:40960
    ds_read_b64_tr_b16 a[86:87], v19 offset:41472
    ds_read_b64_tr_b16 a[92:93], v19 offset:45056
    ds_read_b64_tr_b16 a[94:95], v19 offset:45568
    ds_read_b64_tr_b16 a[100:101], v19 offset:49152
    ds_read_b64_tr_b16 a[102:103], v19 offset:49664
    ds_read_b64_tr_b16 a[108:109], v19 offset:53248
    ds_read_b64_tr_b16 a[110:111], v19 offset:53760
    ds_read_b64_tr_b16 a[116:117], v19 offset:57344
    ds_read_b64_tr_b16 a[118:119], v19 offset:57856
    ds_read_b64_tr_b16 a[124:125], v19 offset:61440
    ds_read_b64_tr_b16 a[126:127], v19 offset:61952
    v_mov_b32 v180, 0
    v_dot2_f32_bf16 v180, v176, s78, v180
    v_dot2_f32_bf16 v180, v177, s78, v180
    v_dot2_f32_bf16 v180, v178, s78, v180
    v_dot2_f32_bf16 v180, v179, s78, v180
    v_cmp_eq_u32 vcc, 1, v3
    s_nop 1
    v_cndmask_b32 v48, 0, v48, vcc
    v_cndmask_b32 v49, 0, v49, vcc
    v_cmp_eq_u32 vcc, 0, v3
    s_nop 1
    v_cndmask_b32 v48, v48, v20, vcc
    v_cndmask_b32 v49, v49, v20, vcc
    v_cmp_eq_u32 vcc, 2, v3
    s_nop 1
    v_cndmask_b32 v50, 0, v20, vcc
    v_cndmask_b32 v51, 0, v20, vcc
    v_add_f32_dpp v180, v180, v180 quad_perm:[1,0,3,2] row_mask:0xf bank_mask:0xf
    s_nop 1
    v_add_f32_dpp v180, v180, v180 quad_perm:[2,3,0,1] row_mask:0xf bank_mask:0xf
    s_nop 1
    v_add_f32_dpp v180, v180, v180 row_half_mirror row_mask:0xf bank_mask:0xf
    s_nop 1
    v_add_f32_dpp v180, v180, v180 row_mirror row_mask:0xf bank_mask:0xf
    v_mov_b32 v178, v180
    s_nop 1
    v_permlane16_swap_b32 v180, v178
    v_add_f32 v180, v180, v178
    v_mov_b32 v178, v180
    s_nop 1
    v_permlane32_swap_b32 v180, v178
    v_add_f32 v180, v180, v178
    s_nop 0
    v_readfirstlane_b32 s93, v180
    s_waitcnt lgkmcnt(0)
    s_barrier
    s_add_u32 m0, s76, 0
    s_add_u32 s52, s53, 0
    buffer_load_dwordx4 v161, s[36:39], s52 offen offset:0 lds
    buffer_load_dwordx4 v161, s[36:39], s52 offen offset:1024 lds
    buffer_load_dwordx4 v161, s[36:39], s52 offen offset:2048 lds
    s_add_u32 m0, s76, 3072
    s_add_u32 s52, s53, 98304
    buffer_load_dwordx4 v161, s[36:39], s52 offen offset:0 lds
    buffer_load_dwordx4 v161, s[36:39], s52 offen offset:1024 lds
    buffer_load_dwordx4 v161, s[36:39], s52 offen offset:2048 lds
    s_add_u32 m0, s76, 6144
    s_add_u32 s52, s53, 196608
    buffer_load_dwordx4 v161, s[36:39], s52 offen offset:0 lds
    buffer_load_dwordx4 v161, s[36:39], s52 offen offset:1024 lds
    buffer_load_dwordx4 v161, s[36:39], s52 offen offset:2048 lds
    s_add_u32 m0, s76, 9216
    s_add_u32 s52, s53, 294912
    buffer_load_dwordx4 v161, s[36:39], s52 offen offset:0 lds
    buffer_load_dwordx4 v161, s[36:39], s52 offen offset:1024 lds
    buffer_load_dwordx4 v161, s[36:39], s52 offen offset:2048 lds
    s_add_u32 m0, s76, 12288
    s_add_u32 s52, s77, 0
    buffer_load_dwordx4 v162, s[40:43], s52 offen lds
    s_add_u32 m0, s76, 13312
    s_add_u32 s52, s77, 32768
    buffer_load_dwordx4 v162, s[40:43], s52 offen lds
    s_add_u32 m0, s76, 14336
    s_add_u32 s52, s77, 65536
    buffer_load_dwordx4 v162, s[40:43], s52 offen lds
    s_add_u32 m0, s76, 15360
    s_add_u32 s52, s77, 98304
    buffer_load_dwordx4 v162, s[40:43], s52 offen lds
    s_waitcnt vmcnt(16)
    s_barrier
    v_xor_b32 v168, 0, v167
    ds_read_b64_tr_b16 a[128:129], v168 offset:0
    ds_read_b64_tr_b16 a[130:131], v168 offset:4096
    ds_read_b64_tr_b16 a[132:133], v168 offset:32768
    ds_read_b64_tr_b16 a[134:135], v168 offset:36864
    v_xor_b32 v168, 32, v167
    ds_read_b64_tr_b16 a[136:137], v168 offset:0
    ds_read_b64_tr_b16 a[138:139], v168 offset:4096
    ds_read_b64_tr_b16 a[140:141], v168 offset:32768
    ds_read_b64_tr_b16 a[142:143], v168 offset:36864
    v_xor_b32 v168, 64, v167
    ds_read_b64_tr_b16 a[144:145], v168 offset:0
    ds_read_b64_tr_b16 a[146:147], v168 offset:4096
    ds_read_b64_tr_b16 a[148:149], v168 offset:32768
    ds_read_b64_tr_b16 a[150:151], v168 offset:36864
    v_xor_b32 v168, 96, v167
    ds_read_b64_tr_b16 a[152:153], v168 offset:0
    ds_read_b64_tr_b16 a[154:155], v168 offset:4096
    ds_read_b64_tr_b16 a[156:157], v168 offset:32768
    ds_read_b64_tr_b16 a[158:159], v168 offset:36864
    v_xor_b32 v168, 128, v167
    ds_read_b64_tr_b16 a[160:161], v168 offset:0
    ds_read_b64_tr_b16 a[162:163], v168 offset:4096
    ds_read_b64_tr_b16 a[164:165], v168 offset:32768
    ds_read_b64_tr_b16 a[166:167], v168 offset:36864
    v_xor_b32 v168, 160, v167
    ds_read_b64_tr_b16 a[168:169], v168 offset:0
    ds_read_b64_tr_b16 a[170:171], v168 offset:4096
    ds_read_b64_tr_b16 a[172:173], v168 offset:32768
    ds_read_b64_tr_b16 a[174:175], v168 offset:36864
    v_xor_b32 v168, 192, v167
    ds_read_b64_tr_b16 a[176:177], v168 offset:0
    ds_read_b64_tr_b16 a[178:179], v168 offset:4096
    ds_read_b64_tr_b16 a[180:181], v168 offset:32768
    ds_read_b64_tr_b16 a[182:183], v168 offset:36864
    v_xor_b32 v168, 224, v167
    ds_read_b64_tr_b16 a[184:185], v168 offset:0
    ds_read_b64_tr_b16 a[186:187], v168 offset:4096
    ds_read_b64_tr_b16 a[188:189], v168 offset:32768
    ds_read_b64_tr_b16 a[190:191], v168 offset:36864
    v_and_b32 v160, 31, v1
    v_lshlrev_b32 v160, 7, v160
    s_mov_b32 s52, 1208320
    s_mov_b32 s95, 0x200000
    s_waitcnt lgkmcnt(0)
Lp_21:
    buffer_load_dwordx2 v[162:163], v160, s[44:47], s52 offen sc1
    s_waitcnt vmcnt(0)
    v_cmp_ne_u32 vcc, s90, v163
    s_nop 0
    s_cmp_eq_u64 vcc, 0
    s_nop 1
    s_cbranch_scc1 Ld_22
    s_sleep 2
    s_sub_u32 s95, s95, 1
    s_cmp_lg_u32 s95, 0
    s_cbranch_scc1 Lp_21
    s_branch L_abort
Ld_22:
    v_cmp_ne_u32 vcc, s81, v162
    s_nop 0
    s_cmp_eq_u64 vcc, 0
    s_cselect_b32 s91, 1, 0
    ds_read_b64_tr_b16 a[192:193], v166 offset:0
    ds_read_b64_tr_b16 a[194:195], v166 offset:256
    ds_read_b64_tr_b16 a[196:197], v166 offset:1024
    ds_read_b64_tr_b16 a[198:199], v166 offset:1280
    ds_read_b64_tr_b16 a[200:201], v166 offset:2048
    ds_read_b64_tr_b16 a[202:203], v166 offset:2304
    ds_read_b64_tr_b16 a[204:205], v166 offset:3072
    ds_read_b64_tr_b16 a[206:207], v166 offset:3328
    ds_read_b64_tr_b16 a[208:209], v166 offset:4096
    ds_read_b64_tr_b16 a[210:211], v166 offset:4352
    ds_read_b64_tr_b16 a[212:213], v166 offset:5120
    ds_read_b64_tr_b16 a[214:215], v166 offset:5376
    ds_read_b64_tr_b16 a[216:217], v166 offset:6144
    ds_read_b64_tr_b16 a[218:219], v166 offset:6400
    ds_read_b64_tr_b16 a[220:221], v166 offset:7168
    ds_read_b64_tr_b16 a[222:223], v166 offset:7424
    ds_read_b64_tr_b16 a[224:225], v166 offset:8192
    ds_read_b64_tr_b16 a[226:227], v166 offset:8448
    ds_read_b64_tr_b16 a[228:229], v166 offset:9216
    ds_read_b64_tr_b16 a[230:231], v166 offset:9472
    ds_read_b64_tr_b16 a[232:233], v166 offset:10240
    ds_read_b64_tr_b16 a[234:235], v166 offset:10496
    ds_read_b64_tr_b16 a[236:237], v166 offset:11264
    ds_read_b64_tr_b16 a[238:239], v166 offset:11520
    ds_read_b64_tr_b16 a[240:241], v166 offset:12288
    ds_read_b64_tr_b16 a[242:243], v166 offset:12544
    ds_read_b64_tr_b16 a[244:245], v166 offset:13312
    ds_read_b64_tr_b16 a[246:247], v166 offset:13568
    ds_read_b64_tr_b16 a[248:249], v166 offset:14336
    ds_read_b64_tr_b16 a[250:251], v166 offset:14592
    ds_read_b64_tr_b16 a[252:253], v166 offset:15360
    ds_read_b64_tr_b16 a[254:255], v166 offset:15616
    s_waitcnt lgkmcnt(15)
    v_mfma_f32_16x16x32_bf16 v[36:39], a[192:195], v[20:23], 0
    v_mfma_f32_16x16x32_bf16 v[40:43], a[196:199], v[20:23], 0
    v_mfma_f32_16x16x32_bf16 v[44:47], v[20:23], a[200:203], 0
    v_mfma_f32_16x16x32_bf16 v[36:39], a[204:207], v[20:23], v[36:39]
    v_mfma_f32_16x16x32_bf16 v[40:43], a[208:211], v[20:23], v[40:43]
    v_mfma_f32_16x16x32_bf16 v[44:47], v[20:23], a[212:215], v[44:47]
    v_mfma_f32_16x16x32_bf16 v[36:39], a[216:219], v[20:23], v[36:39]
    v_mfma_f32_16x16x32_bf16 v[40:43], a[220:223], v[20:23], v[40:43]
    s_waitcnt lgkmcnt(14)
    v_mfma_f32_16x16x32_bf16 v[44:47], v[20:23], a[224:227], v[44:47]
    s_waitcnt lgkmcnt(12)
    v_mfma_f32_16x16x32_bf16 v[36:39], a[228:231], v[20:23], v[36:39]
    s_waitcnt lgkmcnt(10)
    v_mfma_f32_16x16x32_bf16 v[40:43], a[232:235], v[20:23], v[40:43]
    s_waitcnt lgkmcnt(8)
    v_mfma_f32_16x16x32_bf16 v[44:47], v[20:23], a[236:239], v[44:47]
    s_nop 3
    ds_write_b128 v182, v[36:39] offset:0
    s_nop 0
    ds_write_b128 v182, v[40:43] offset:1024
    s_nop 0
    ds_write_b128 v182, v[44:47] offset:2048
    s_waitcnt lgkmcnt(0)
    s_barrier
    ds_read_b128 v[96:99], v183 offset:0
    ds_read_b128 v[100:103], v183 offset:1024
    ds_read_b128 v[104:107], v183 offset:2048
    ds_read_b128 v[108:111], v183 offset:3072
    ds_read_b128 v[112:115], v183 offset:4096
    ds_read_b128 v[116:119], v183 offset:5120
    ds_read_b128 v[120:123], v183 offset:6144
    ds_read_b128 v[124:127], v183 offset:7168
    ds_read_b128 v[128:131], v183 offset:8192
    ds_read_b128 v[132:135], v183 offset:9216
    ds_read_b128 v[136:139], v183 offset:10240
    ds_read_b128 v[140:143], v183 offset:11264
    s_waitcnt lgkmcnt(8)
    v_pk_add_f32 v[96:97], v[96:97], v[108:109]
    s_waitcnt lgkmcnt(2)
    v_pk_add_f32 v[120:121], v[120:121], v[132:133]
    v_pk_add_f32 v[36:37], v[96:97], v[120:121]
    v_pk_add_f32 v[98:99], v[98:99], v[110:111]
    v_pk_add_f32 v[122:123], v[122:123], v[134:135]
    v_pk_add_f32 v[38:39], v[98:99], v[122:123]
    v_pk_add_f32 v[100:101], v[100:101], v[112:113]
    s_waitcnt lgkmcnt(1)
    v_pk_add_f32 v[124:125], v[124:125], v[136:137]
    v_pk_add_f32 v[40:41], v[100:101], v[124:125]
    v_pk_add_f32 v[102:103], v[102:103], v[114:115]
    v_pk_add_f32 v[126:127], v[126:127], v[138:139]
    v_pk_add_f32 v[42:43], v[102:103], v[126:127]
    v_pk_add_f32 v[104:105], v[104:105], v[116:117]
    s_waitcnt lgkmcnt(0)
    v_pk_add_f32 v[128:129], v[128:129], v[140:141]
    v_pk_add_f32 v[44:45], v[104:105], v[128:129]
    v_mov_b32 v160, 154624
    v_mov_b32 v162, 0
    v_mov_b32 v163, 0
    v_lshl_add_u32 v160, v3, 3, v160
    ds_write_b64 v160, v[162:163]
    v_lshlrev_b32 v79, 4, v1
    v_lshrrev_b32 v160, 1, v1
    s_mov_b32 s52, 267776
    v_mul_lo_u32 v8, v160, s52
    v_and_b32 v160, 1, v1
    v_lshl_add_u32 v8, v160, 11, v8
    v_add_u32 v8, 2272256, v8
    v_mov_b32 v4, 0
    v_mov_b32 v7, s90
    v_lshlrev_b32 v9, 3, v0
    v_lshlrev_b32 v10, 2, v0
    v_add_u32 v10, 147456, v10
    v_and_b32 v160, 1, v3
    v_mul_u32_u24 v11, 1088, v160
    v_lshl_add_u32 v11, v2, 4, v11
    v_add_u32 v11, 147456, v11
    v_mul_u32_u24 v161, 144, v160
    v_lshl_add_u32 v161, v2, 4, v161
    v_add_u32 v161, 151680, v161
    v_mov_b32 v162, 154624
    v_lshrrev_b32 v163, 1, v3
    v_cmp_eq_u32 vcc, 0, v163
    s_nop 1
    v_cndmask_b32 v14, v162, v161, vcc
    v_cmp_eq_u32 vcc, 2, v163
    s_nop 1
    v_cndmask_b32 v15, v162, v161, vcc
    v_cmp_eq_u32 vcc, 4, v163
    s_nop 1
    v_cndmask_b32 v16, v162, v161, vcc
    v_cmp_eq_u32 vcc, 6, v163
    s_nop 1
    v_cndmask_b32 v17, v162, v161, vcc
    s_lshl_b32 s52, s3, 5
    s_add_u32 s52, s52, 151680
    v_lshlrev_b32 v12, 1, v3
    v_add_u32 v12, s52, v12
    v_lshlrev_b32 v13, 4, v3
    v_lshl_add_u32 v13, v2, 13, v13
    s_mov_b32 s55, 267776
    v_mul_lo_u32 v80, v1, s55
    s_lshl_b32 s55, s5, 2
    s_add_u32 s55, s55, s3
    s_cmp_eq_u32 s55, 127
    s_cselect_b64 s[28:29], 0xfffffff, 0
L_Floop:
    s_mul_i32 s52, s92, 2048
    s_add_u32 s52, s52, 4096
    s_mul_i32 s76, s92, 262144
    s_add_u32 s76, s76, 196608
    s_lshl_b32 s53, s5, 13
    s_add_u32 s53, s53, s76
    s_lshl_b32 s54, s3, 11
    s_add_u32 s22, s53, s54
    s_lshl_b32 s53, s5, 8
    s_add_u32 s23, s53, s76
    s_cmp_lt_u32 s5, 28
    s_cselect_b64 s[100:101], -1, 0
    s_mov_b32 exec_hi, 0xffffff
    s_mov_b32 s95, 0x200000
Lp_23:
    buffer_load_dwordx4 v[4:7], v79, s[44:47], s52 offen sc1
    s_waitcnt vmcnt(0)
    v_cmp_ne_u32 vcc, s90, v7
    s_nop 0
    s_cmp_eq_u64 vcc, 0
    s_nop 1
    s_cbranch_scc1 Ld_24
    s_sleep 1
    s_sub_u32 s95, s95, 1
    s_cmp_lg_u32 s95, 0
    s_cbranch_scc1 Lp_23
    s_branch L_abort
Ld_24:
    s_mov_b32 exec_hi, -1
    v_mov_b32 v168, v4
    s_nop 1
    v_max_u32_dpp v168, v168, v168 quad_perm:[1,0,3,2] row_mask:0xf bank_mask:0xf
    s_nop 1
    v_max_u32_dpp v168, v168, v168 quad_perm:[2,3,0,1] row_mask:0xf bank_mask:0xf
    s_nop 1
    v_max_u32_dpp v168, v168, v168 row_half_mirror row_mask:0xf bank_mask:0xf
    s_nop 1
    v_max_u32_dpp v168, v168, v168 row_mirror row_mask:0xf bank_mask:0xf
    s_nop 1
    v_max_u32_dpp v168, v168, v168 row_bcast:15 row_mask:0xa bank_mask:0xf
    s_nop 1
    v_max_u32_dpp v168, v168, v168 row_bcast:31 row_mask:0xc bank_mask:0xf
    s_nop 0
    v_readlane_b32 s70, v168, 63
    s_nop 1
    v_cmp_ne_u32 vcc, s70, v4
    s_nop 1
    v_cndmask_b32 v168, 0, v4, vcc
    s_nop 1
    v_max_u32_dpp v168, v168, v168 quad_perm:[1,0,3,2] row_mask:0xf bank_mask:0xf
    s_nop 1
    v_max_u32_dpp v168, v168, v168 quad_perm:[2,3,0,1] row_mask:0xf bank_mask:0xf
    s_nop 1
    v_max_u32_dpp v168, v168, v168 row_half_mirror row_mask:0xf bank_mask:0xf
    s_nop 1
    v_max_u32_dpp v168, v168, v168 row_mirror row_mask:0xf bank_mask:0xf
    s_nop 1
    v_max_u32_dpp v168, v168, v168 row_bcast:15 row_mask:0xa bank_mask:0xf
    s_nop 1
    v_max_u32_dpp v168, v168, v168 row_bcast:31 row_mask:0xc bank_mask:0xf
    s_nop 0
    v_readlane_b32 s71, v168, 63
    v_cmp_eq_u32 vcc, s70, v4
    s_nop 0
    s_ff1_i32_b64 s10, vcc
    s_nop 0
    v_readlane_b32 s76, v8, s10
    v_cmp_eq_u32 vcc, s71, v4
    s_nop 0
    s_ff1_i32_b64 s11, vcc
    s_nop 0
    v_readlane_b32 s77, v8, s11
    buffer_load_dwordx2 v[164:165], v9, s[44:47], s76 offen sc1
    s_nop 3
    buffer_load_dwordx2 v[166:167], v9, s[44:47], s77 offen sc1
    v_readlane_b32 s82, v5, s10
    v_readlane_b32 s83, v6, s10
    v_readlane_b32 s84, v5, s11
    v_readlane_b32 s85, v6, s11
    v_mov_b32 v168, s70
    v_mov_b32 v169, s90
    v_mov_b32 v170, s71
    v_mov_b32 v171, s90
    s_lshl_b32 s55, s92, 7
    s_add_u32 s55, s55, 2272000
    s_mov_b64 exec, s[28:29]
    buffer_store_dwordx4 v[168:171], v80, s[44:47], s55 offen sc1
    s_mov_b64 exec, -1
    s_waitcnt vmcnt(1)
    v_cmp_ne_u32 vcc, s90, v165
    v_cmp_ne_u32 s[96:97], s90, v167
    s_nop 0
    s_or_b64 vcc, vcc, s[96:97]
    s_cmp_eq_u64 vcc, 0
    s_nop 0
    s_cbranch_scc1 Lq_25
    s_mov_b32 s95, 0x200000
Lp_26:
    buffer_load_dwordx2 v[164:165], v9, s[44:47], s76 offen sc1
    buffer_load_dwordx2 v[166:167], v9, s[44:47], s77 offen sc1
    s_waitcnt vmcnt(0)
    v_cmp_ne_u32 vcc, s90, v165
    v_cmp_ne_u32 s[96:97], s90, v167
    s_nop 0
    s_or_b64 vcc, vcc, s[96:97]
    s_cmp_eq_u64 vcc, 0
    s_nop 0
    s_cbranch_scc1 Ld_27
    s_sub_u32 s95, s95, 1
    s_cmp_lg_u32 s95, 0
    s_cbranch_scc1 Lp_26
    s_branch L_abort
Ld_27:
Lq_25:
    v_lshlrev_b32 v170, 16, v164
    v_lshlrev_b32 v172, 16, v166
    v_and_b32 v171, 0xffff0000, v164
    v_and_b32 v173, 0xffff0000, v166
    v_subrev_f32 v170, s82, v170
    v_subrev_f32 v172, s84, v172
    v_subrev_f32 v171, s82, v171
    v_subrev_f32 v173, s84, v173
    v_mul_f32 v170, s83, v170
    v_mul_f32 v172, s85, v172
    v_mul_f32 v171, s83, v171
    v_mul_f32 v173, s85, v173
    v_cvt_pk_bf16_f32 v170, v170, v171
    v_cvt_pk_bf16_f32 v172, v172, v173
    ds_write_b32 v10, v170 offset:0
    ds_write_b32 v10, v172 offset:1088
    s_waitcnt lgkmcnt(0)
    s_barrier
    ds_read_b128 v[96:99], v11 offset:0
    ds_read_b128 v[100:103], v11 offset:64
    ds_read_b128 v[104:107], v11 offset:128
    ds_read_b128 v[108:111], v11 offset:192
    s_waitcnt lgkmcnt(3)
    v_mfma_f32_16x16x32_bf16 v[180:183], v[96:99], a[0:3], 0
    ds_read_b128 v[112:115], v11 offset:256
    v_mfma_f32_16x16x32_bf16 v[184:187], v[96:99], a[4:7], 0
    ds_read_b128 v[116:119], v11 offset:320
    s_waitcnt lgkmcnt(4)
    v_mfma_f32_16x16x32_bf16 v[180:183], v[100:103], a[8:11], v[180:183]
    ds_read_b128 v[120:123], v11 offset:384
    v_mfma_f32_16x16x32_bf16 v[184:187], v[100:103], a[12:15], v[184:187]
    ds_read_b128 v[124:127], v11 offset:448
    s_waitcnt lgkmcnt(5)
    v_mfma_f32_16x16x32_bf16 v[180:183], v[104:107], a[16:19], v[180:183]
    ds_read_b128 v[128:131], v11 offset:512
    v_mfma_f32_16x16x32_bf16 v[184:187], v[104:107], a[20:23], v[184:187]
    ds_read_b128 v[132:135], v11 offset:576
    s_waitcnt lgkmcnt(6)
    v_mfma_f32_16x16x32_bf16 v[180:183], v[108:111], a[24:27], v[180:183]
    ds_read_b128 v[136:139], v11 offset:640
    v_mfma_f32_16x16x32_bf16 v[184:187], v[108:111], a[28:31], v[184:187]
    ds_read_b128 v[140:143], v11 offset:704
    s_waitcnt lgkmcnt(7)
    v_mfma_f32_16x16x32_bf16 v[180:183], v[112:115], a[32:35], v[180:183]
    ds_read_b128 v[144:147], v11 offset:768
    v_mfma_f32_16x16x32_bf16 v[184:187], v[112:115], a[36:39], v[184:187]
    ds_read_b128 v[148:151], v11 offset:832
    s_waitcnt lgkmcnt(8)
    v_mfma_f32_16x16x32_bf16 v[180:183], v[116:119], a[40:43], v[180:183]
    ds_read_b128 v[152:155], v11 offset:896
    v_mfma_f32_16x16x32_bf16 v[184:187], v[116:119], a[44:47], v[184:187]
    ds_read_b128 v[156:159], v11 offset:960
    s_waitcnt lgkmcnt(9)
    v_mfma_f32_16x16x32_bf16 v[180:183], v[120:123], a[48:51], v[180:183]
    ds_write_b32 v10, v164 offset:2176
    v_mfma_f32_16x16x32_bf16 v[184:187], v[120:123], a[52:55], v[184:187]
    ds_write_b32 v10, v166 offset:3200
    s_waitcnt lgkmcnt(10)
    v_mfma_f32_16x16x32_bf16 v[180:183], v[124:127], a[56:59], v[180:183]
    v_mov_b32 v64, v164
    v_mov_b32 v65, v166
    v_mfma_f32_16x16x32_bf16 v[184:187], v[124:127], a[60:63], v[184:187]
    s_and_b32 s53, s70, 0xfffff800
    s_or_b32 s53, s53, 0x400
    s_waitcnt lgkmcnt(9)
    v_mfma_f32_16x16x32_bf16 v[180:183], v[128:131], a[64:67], v[180:183]
    s_ashr_i32 s54, s53, 31
    s_not_b32 s54, s54
    v_mfma_f32_16x16x32_bf16 v[184:187], v[128:131], a[68:71], v[184:187]
    s_or_b32 s54, s54, 0x80000000
    s_xor_b32 s53, s53, s54
    s_waitcnt lgkmcnt(8)
    v_mfma_f32_16x16x32_bf16 v[180:183], v[132:135], a[72:75], v[180:183]
    v_mov_b32 v176, s53
    v_cvt_pk_bf16_f32 v176, v176, v176
    v_mfma_f32_16x16x32_bf16 v[184:187], v[132:135], a[76:79], v[184:187]
    v_lshlrev_b32 v176, 16, v176
    v_mul_f32 v176, 0xbfb8aa3b, v176
    s_waitcnt lgkmcnt(5)
    v_mfma_f32_16x16x32_bf16 v[180:183], v[136:139], a[80:83], v[180:183]
    v_exp_f32 v176, v176
    v_mfma_f32_16x16x32_bf16 v[184:187], v[136:139], a[84:87], v[184:187]
    v_add_f32 v176, 1.0, v176
    v_mfma_f32_16x16x32_bf16 v[180:183], v[140:143], a[88:91], v[180:183]
    v_rcp_f32 v176, v176
    v_mfma_f32_16x16x32_bf16 v[184:187], v[140:143], a[92:95], v[184:187]
    v_cvt_pk_bf16_f32 v176, v176, v176
    v_lshlrev_b32 v176, 16, v176
    v_mfma_f32_16x16x32_bf16 v[180:183], v[144:147], a[96:99], v[180:183]
    s_and_b32 s53, s71, 0xfffff800
    s_or_b32 s53, s53, 0x400
    v_mfma_f32_16x16x32_bf16 v[184:187], v[144:147], a[100:103], v[184:187]
    s_ashr_i32 s54, s53, 31
    s_not_b32 s54, s54
    s_waitcnt lgkmcnt(0)
    v_mfma_f32_16x16x32_bf16 v[180:183], v[148:151], a[104:107], v[180:183]
    s_or_b32 s54, s54, 0x80000000
    s_xor_b32 s53, s53, s54
    v_mfma_f32_16x16x32_bf16 v[184:187], v[148:151], a[108:111], v[184:187]
    v_mov_b32 v177, s53
    v_cvt_pk_bf16_f32 v177, v177, v177
    v_mfma_f32_16x16x32_bf16 v[180:183], v[152:155], a[112:115], v[180:183]
    v_lshlrev_b32 v177, 16, v177
    v_mul_f32 v177, 0xbfb8aa3b, v177
    v_mfma_f32_16x16x32_bf16 v[184:187], v[152:155], a[116:119], v[184:187]
    v_exp_f32 v177, v177
    v_mfma_f32_16x16x32_bf16 v[180:183], v[156:159], a[120:123], v[180:183]
    v_add_f32 v177, 1.0, v177
    v_rcp_f32 v177, v177
    v_mfma_f32_16x16x32_bf16 v[184:187], v[156:159], a[124:127], v[184:187]
    v_cvt_pk_bf16_f32 v177, v177, v177
    v_lshlrev_b32 v177, 16, v177
    s_nop 2
    v_mul_f32 v172, 0xbfb8aa3b, v180
    v_mul_f32 v173, 0xbfb8aa3b, v181
    v_cvt_pk_bf16_f32 v180, v180, v180
    v_cvt_pk_bf16_f32 v181, v181, v181
    v_exp_f32 v172, v172
    v_exp_f32 v173, v173
    v_lshlrev_b32 v180, 16, v180
    v_lshlrev_b32 v181, 16, v181
    v_add_f32 v172, 1.0, v172
    v_add_f32 v173, 1.0, v173
    v_cvt_pk_bf16_f32 v184, v184, v184
    v_cvt_pk_bf16_f32 v185, v185, v185
    v_rcp_f32 v172, v172
    v_rcp_f32 v173, v173
    v_lshlrev_b32 v184, 16, v184
    v_lshlrev_b32 v185, 16, v185
    v_mul_f32 v180, v180, v172
    v_mul_f32 v181, v181, v173
    v_cvt_pk_bf16_f32 v180, v180, v180
    v_cvt_pk_bf16_f32 v181, v181, v181
    v_lshlrev_b32 v180, 16, v180
    v_lshlrev_b32 v181, 16, v181
    v_mul_f32 v180, v180, v184
    v_mul_f32 v181, v181, v185
    v_cvt_pk_bf16_f32 v180, v180, v181
    ds_write_b16 v12, v180
    ds_write_b16_d16_hi v12, v180 offset:144
    s_waitcnt lgkmcnt(0)
    s_barrier
    ds_read_b128 v[96:99], v14 offset:0
    ds_read_b128 v[100:103], v14 offset:64
    ds_read_b128 v[104:107], v15 offset:0
    ds_read_b128 v[108:111], v15 offset:64
    ds_read_b128 v[112:115], v16 offset:0
    ds_read_b128 v[116:119], v16 offset:64
    ds_read_b128 v[120:123], v17 offset:0
    ds_read_b128 v[124:127], v17 offset:64
    s_waitcnt lgkmcnt(7)
    v_mfma_f32_16x16x32_bf16 v[128:131], v[96:99], a[128:131], 0
    v_mfma_f32_16x16x32_bf16 v[132:135], v[96:99], a[160:163], 0
    s_waitcnt lgkmcnt(6)
    v_mfma_f32_16x16x32_bf16 v[128:131], v[100:103], a[132:135], v[128:131]
    v_mfma_f32_16x16x32_bf16 v[132:135], v[100:103], a[164:167], v[132:135]
    s_waitcnt lgkmcnt(5)
    v_mfma_f32_16x16x32_bf16 v[128:131], v[104:107], a[136:139], v[128:131]
    v_mfma_f32_16x16x32_bf16 v[132:135], v[104:107], a[168:171], v[132:135]
    s_waitcnt lgkmcnt(4)
    v_mfma_f32_16x16x32_bf16 v[128:131], v[108:111], a[140:143], v[128:131]
    v_mfma_f32_16x16x32_bf16 v[132:135], v[108:111], a[172:175], v[132:135]
    s_waitcnt lgkmcnt(3)
    v_mfma_f32_16x16x32_bf16 v[128:131], v[112:115], a[144:147], v[128:131]
    v_mfma_f32_16x16x32_bf16 v[132:135], v[112:115], a[176:179], v[132:135]
    s_waitcnt lgkmcnt(2)
    v_mfma_f32_16x16x32_bf16 v[128:131], v[116:119], a[148:151], v[128:131]
    v_mfma_f32_16x16x32_bf16 v[132:135], v[116:119], a[180:183], v[132:135]
    s_waitcnt lgkmcnt(1)
    v_mfma_f32_16x16x32_bf16 v[128:131], v[120:123], a[152:155], v[128:131]
    v_mfma_f32_16x16x32_bf16 v[132:135], v[120:123], a[184:187], v[132:135]
    s_waitcnt lgkmcnt(0)
    v_mfma_f32_16x16x32_bf16 v[128:131], v[124:127], a[156:159], v[128:131]
    v_mfma_f32_16x16x32_bf16 v[132:135], v[124:127], a[188:191], v[132:135]
    s_mov_b64 exec, s[100:101]
    s_nop 5
    v_mov_b32 v131, s90
    v_mov_b32 v135, s90
    s_cmp_eq_u32 s91, 1
    s_cbranch_scc0 Ls_28
    buffer_store_dwordx4 v[128:131], v79, s[44:47], s22 offen offset:0
    buffer_store_dwordx4 v[132:135], v79, s[44:47], s22 offen offset:1024
    s_nop 0
    s_branch Le_29
Ls_28:
    buffer_store_dwordx4 v[128:131], v79, s[44:47], s22 offen offset:0 sc1
    buffer_store_dwordx4 v[132:135], v79, s[44:47], s22 offen offset:1024 sc1
Le_29:
    s_mov_b64 exec, -1
    s_cmp_lg_u32 s3, 0
    s_cbranch_scc1 L_Fnb
    s_cmp_eq_u32 s92, 0
    s_cbranch_scc1 Ln_30
    v_add_f32 v160, 1.0, v76
    v_mul_f32 v161, -v75, v76
    v_pk_fma_f32 v[70:71], v[70:71], v[160:161], v[160:161] op_sel:[0,0,1] op_sel_hi:[1,0,1]
    v_pk_fma_f32 v[72:73], v[72:73], v[160:161], v[160:161] op_sel:[0,0,1] op_sel_hi:[1,0,1]
    v_cvt_pk_bf16_f32 v160, v70, v71
    v_cvt_pk_bf16_f32 v161, v72, v73
    v_lshlrev_b32 v162, 10, v77
    v_lshl_add_u32 v162, v2, 3, v162
    s_lshl_b32 s52, s5, 5
    v_cmp_ne_u32 vcc, 0, v74
    v_cmp_ne_u32 s[96:97], s70, v74
    s_nop 0
    s_and_b64 vcc, vcc, s[96:97]
    v_cmp_ne_u32 s[96:97], s71, v74
    s_nop 0
    s_and_b64 exec, vcc, s[96:97]
    buffer_store_dwordx2 v[160:161], v162, s[48:51], s52 offen
    s_mov_b64 exec, -1
Ln_30:
    s_lshl_b32 s52, s5, 5
    s_add_u32 s52, s52, 149632
    v_lshlrev_b32 v163, 1, v3
    v_add_u32 v163, s52, v163
    ds_read_u16 v178, v163
    ds_read_u16 v179, v163 offset:1024
    s_waitcnt lgkmcnt(1)
    v_lshlrev_b32 v178, 16, v178
    s_waitcnt lgkmcnt(0)
    v_lshlrev_b32 v179, 16, v179
    v_subrev_f32 v180, s82, v178
    v_subrev_f32 v181, s84, v179
    v_mul_f32 v180, s83, v180
    v_mul_f32 v181, s85, v181
    v_cvt_pk_bf16_f32 v180, v180, v180
    v_cvt_pk_bf16_f32 v181, v181, v181
    v_lshlrev_b32 v180, 16, v180
    v_lshlrev_b32 v181, 16, v181
    s_and_b32 s74, s70, 0x7ff
    s_and_b32 s75, s71, 0x7ff
    s_lshl_b32 s74, s74, 10
    s_lshl_b32 s75, s75, 10
    s_lshl_b32 s53, s5, 5
    s_lshl_b32 s53, s5, 5
    s_add_u32 s74, s74, s53
    s_add_u32 s75, s75, s53
    v_lshlrev_b32 v182, 1, v3
    s_mov_b32 s95, 0x200000
Lp_31:
    s_add_u32 s52, s23, 0
    buffer_load_dwordx4 v[136:139], v13, s[44:47], s52 offen sc1
    s_add_u32 s52, s23, 32768
    buffer_load_dwordx4 v[140:143], v13, s[44:47], s52 offen sc1
    s_add_u32 s52, s23, 65536
    buffer_load_dwordx4 v[144:147], v13, s[44:47], s52 offen sc1
    s_add_u32 s52, s23, 98304
    buffer_load_dwordx4 v[148:151], v13, s[44:47], s52 offen sc1
    s_add_u32 s52, s23, 131072
    buffer_load_dwordx4 v[152:155], v13, s[44:47], s52 offen sc1
    s_add_u32 s52, s23, 163840
    buffer_load_dwordx4 v[156:159], v13, s[44:47], s52 offen sc1
    s_add_u32 s52, s23, 196608
    buffer_load_dwordx4 v[160:163], v13, s[44:47], s52 offen sc1
    s_waitcnt vmcnt(0)
    v_cmp_ne_u32 vcc, s90, v139
    v_cmp_ne_u32 s[96:97], s90, v143
    s_nop 0
    s_or_b64 vcc, vcc, s[96:97]
    v_cmp_ne_u32 s[96:97], s90, v147
    s_nop 0
    s_or_b64 vcc, vcc, s[96:97]
    v_cmp_ne_u32 s[96:97], s90, v151
    s_nop 0
    s_or_b64 vcc, vcc, s[96:97]
    v_cmp_ne_u32 s[96:97], s90, v155
    s_nop 0
    s_or_b64 vcc, vcc, s[96:97]
    v_cmp_ne_u32 s[96:97], s90, v159
    s_nop 0
    s_or_b64 vcc, vcc, s[96:97]
    v_cmp_ne_u32 s[96:97], s90, v163
    s_nop 0
    s_or_b64 vcc, vcc, s[96:97]
    s_cmp_eq_u64 vcc, 0
    s_nop 0
    s_cbranch_scc1 Ld_32
    s_sub_u32 s95, s95, 1
    s_cmp_lg_u32 s95, 0
    s_cbranch_scc1 Lp_31
    s_branch L_abort
Ld_32:
    v_pk_add_f32 v[136:137], v[136:137], v[148:149]
    v_pk_add_f32 v[140:141], v[140:141], v[152:153]
    v_pk_add_f32 v[144:145], v[144:145], v[156:157]
    v_pk_add_f32 v[136:137], v[136:137], v[160:161]
    v_pk_add_f32 v[140:141], v[140:141], v[144:145]
    v_pk_add_f32 v[164:165], v[136:137], v[140:141]
    v_mov_b32 v166, v164
    v_mov_b32 v167, v165
    s_nop 0
    v_permlane16_swap_b32 v164, v166
    v_permlane16_swap_b32 v165, v167
    v_add_f32 v164, v164, v166
    v_add_f32 v165, v165, v167
    v_mov_b32 v166, v164
    v_mov_b32 v167, v165
    s_nop 0
    v_permlane32_swap_b32 v164, v166
    v_permlane32_swap_b32 v165, v167
    v_add_f32 v164, v164, v166
    v_add_f32 v165, v165, v167
    v_cvt_pk_bf16_f32 v164, v164, v164
    v_cvt_pk_bf16_f32 v165, v165, v165
    v_lshlrev_b32 v164, 16, v164
    v_lshlrev_b32 v165, 16, v165
    v_mul_f32 v164, v164, v176
    v_mul_f32 v165, v165, v177
    v_cvt_pk_bf16_f32 v164, v164, v164
    v_cvt_pk_bf16_f32 v165, v165, v165
    v_lshlrev_b32 v164, 16, v164
    v_lshlrev_b32 v165, 16, v165
    s_cmp_lg_u32 s92, 0
    s_cbranch_scc1 L_Fout
    v_mov_b32_dpp v166, v164 quad_perm:[1,0,3,2] row_mask:0xf bank_mask:0xf
    v_mov_b32_dpp v167, v165 quad_perm:[1,0,3,2] row_mask:0xf bank_mask:0xf
    v_cvt_pk_bf16_f32 v168, v164, v166
    v_mov_b32 v169, s90
    v_cvt_pk_bf16_f32 v170, v165, v167
    v_mov_b32 v171, s90
    v_lshlrev_b32 v161, 2, v3
    s_lshl_b32 s52, s5, 6
    s_add_u32 s52, s52, 8192
    s_mov_b64 exec, 0x5555
    s_cmp_eq_u32 s91, 1
    s_cbranch_scc0 Ls_33
    buffer_store_dwordx2 v[168:169], v161, s[44:47], s52 offen
    buffer_store_dwordx2 v[170:171], v161, s[44:47], s52 offen offset:2048
    s_branch Le_34
Ls_33:
    buffer_store_dwordx2 v[168:169], v161, s[44:47], s52 offen sc1
    buffer_store_dwordx2 v[170:171], v161, s[44:47], s52 offen offset:2048 sc1
Le_34:
    s_mov_b64 exec, -1
    s_and_b32 s8, s70, 0x7ff
    s_and_b32 s9, s71, 0x7ff
    s_lshr_b32 s52, s8, 1
    s_sub_i32 s12, 7, s52
    s_max_i32 s12, s12, 0
    s_sub_i32 s13, 1030, s52
    s_min_i32 s13, s13, 15
    s_lshr_b32 s52, s9, 1
    s_sub_i32 s14, 7, s52
    s_max_i32 s14, s14, 0
    s_sub_i32 s15, 1030, s52
    s_min_i32 s15, s15, 15
    s_sub_i32 s52, s8, s9
    s_ashr_i32 s24, s52, 1
    s_add_i32 s24, s24, 7
    s_bitcmp1_b32 s52, 0
    s_cselect_b32 s24, 16, s24
    s_min_u32 s24, s24, 16
    s_sub_i32 s52, s9, s8
    s_ashr_i32 s25, s52, 1
    s_add_i32 s25, s25, 7
    s_bitcmp1_b32 s52, 0
    s_cselect_b32 s25, 16, s25
    s_min_u32 s25, s25, 16
    s_branch L_Fred
L_Fnb:
    s_cmp_lg_u32 s92, 0
    s_cbranch_scc1 L_fin
    s_and_b32 s8, s70, 0x7ff
    s_and_b32 s9, s71, 0x7ff
    s_lshr_b32 s52, s8, 1
    s_sub_i32 s12, 7, s52
    s_max_i32 s12, s12, 0
    s_sub_i32 s13, 1030, s52
    s_min_i32 s13, s13, 15
    s_lshr_b32 s52, s9, 1
    s_sub_i32 s14, 7, s52
    s_max_i32 s14, s14, 0
    s_sub_i32 s15, 1030, s52
    s_min_i32 s15, s15, 15
    s_sub_i32 s52, s8, s9
    s_ashr_i32 s24, s52, 1
    s_add_i32 s24, s24, 7
    s_bitcmp1_b32 s52, 0
    s_cselect_b32 s24, 16, s24
    s_min_u32 s24, s24, 16
    s_sub_i32 s52, s9, s8
    s_ashr_i32 s25, s52, 1
    s_add_i32 s25, s25, 7
    s_bitcmp1_b32 s52, 0
    s_cselect_b32 s25, 16, s25
    s_min_u32 s25, s25, 16
    s_lshr_b32 s52, s10, 1
    s_mul_i32 s16, s52, 267776
    s_add_u32 s16, s16, 2097152
    s_cmp_ge_u32 s52, 14
    s_cselect_b32 s53, 14, 0
    s_sub_u32 s52, s52, s53
    s_mul_i32 s52, s52, 73
    s_add_u32 s52, s52, 7
    s_lshr_b32 s18, s8, 1
    s_sub_i32 s18, s18, s52
    s_lshr_b32 s52, s11, 1
    s_mul_i32 s17, s52, 267776
    s_add_u32 s17, s17, 2097152
    s_cmp_ge_u32 s52, 14
    s_cselect_b32 s53, 14, 0
    s_sub_u32 s52, s52, s53
    s_mul_i32 s52, s52, 73
    s_add_u32 s52, s52, 7
    s_lshr_b32 s19, s9, 1
    s_sub_i32 s19, s19, s52
    v_and_b32 v200, 31, v1
    v_lshlrev_b32 v200, 2, v200
    v_cmp_lt_u32 vcc, 31, v1
    s_add_i32 s52, s18, s13
    s_cmp_gt_i32 s52, 79
    s_cselect_b32 s52, 267776, 0
    v_mov_b32 v201, s52
    v_cndmask_b32 v201, 0, v201, vcc
    v_add_u32 v201, v201, v200
    s_add_u32 s20, s16, 267520
    s_add_i32 s52, s19, s15
    s_cmp_gt_i32 s52, 79
    s_cselect_b32 s52, 267776, 0
    v_mov_b32 v202, s52
    v_cndmask_b32 v202, 0, v202, vcc
    v_add_u32 v202, v202, v200
    s_add_u32 s21, s17, 267520
    buffer_load_dword v204, v201, s[44:47], s20 offen sc1
    buffer_load_dword v205, v202, s[44:47], s21 offen sc1
    v_bfe_u32 v206, v0, 2, 4
    v_bfe_u32 v207, v0, 6, 1
    v_cmp_eq_u32 vcc, 1, v207
    v_mov_b32 v208, s12
    v_mov_b32 v211, s14
    v_cndmask_b32 v208, v208, v211, vcc
    v_mov_b32 v209, s13
    v_mov_b32 v211, s15
    v_cndmask_b32 v209, v209, v211, vcc
    v_med3_u32 v206, v206, v208, v209
    v_mov_b32 v208, s18
    v_mov_b32 v211, s19
    v_cndmask_b32 v208, v208, v211, vcc
    v_mov_b32 v209, s16
    v_mov_b32 v211, s17
    v_cndmask_b32 v209, v209, v211, vcc
    v_add_u32 v206, v206, v208
    v_cmp_lt_u32 vcc, 79, v206
    v_lshlrev_b32 v206, 4, v206
    v_add_u32 v208, 266608, v206
    v_cndmask_b32 v206, v206, v208, vcc
    v_and_b32 v207, 3, v0
    v_lshl_add_u32 v206, v207, 2, v206
    v_add_u32 v206, v206, v209
    v_bfe_u32 v208, v0, 2, 5
    v_lshlrev_b32 v208, 2, v208
    v_lshl_add_u32 v208, v207, 7, v208
    v_add_u32 v208, 152576, v208
    v_lshlrev_b32 v209, 4, v1
    v_and_b32 v212, 15, v1
    v_bfe_u32 v213, v1, 4, 1
    v_cmp_eq_u32 vcc, 1, v213
    v_mov_b32 v213, s12
    v_mov_b32 v211, s14
    v_cndmask_b32 v213, v213, v211, vcc
    v_mov_b32 v214, s13
    v_mov_b32 v211, s15
    v_cndmask_b32 v214, v214, v211, vcc
    v_med3_u32 v213, v212, v213, v214
    v_mov_b32 v214, s18
    v_mov_b32 v211, s19
    v_cndmask_b32 v214, v214, v211, vcc
    v_add_u32 v213, v213, v214
    v_mov_b32 v214, s16
    v_mov_b32 v211, s17
    v_cndmask_b32 v214, v214, v211, vcc
    v_mov_b32 v215, s25
    v_mov_b32 v211, s24
    v_cndmask_b32 v215, v215, v211, vcc
    v_cmp_lt_u32 vcc, 79, v213
    v_lshlrev_b32 v213, 10, v213
    v_add_u32 v216, 193024, v213
    v_cndmask_b32 v213, v213, v216, vcc
    v_add_u32 v213, v213, v214
    v_add_u32 v213, 184320, v213
    v_cmp_eq_u32 vcc, v212, v215
    v_cmp_eq_u32 s[96:97], 7, v212
    s_nop 0
    s_or_b64 vcc, vcc, s[96:97]
    v_cndmask_b32 v212, v213, -1, vcc
    v_lshlrev_b32 v220, 2, v0
    v_xor_b32 v221, 112, v220
    s_lshl_b32 s53, s25, 4
    s_lshl_b32 s54, s25, 10
    s_add_u32 s54, s54, 0
    s_cmp_ge_u32 s25, 16
    s_cselect_b32 s54, 90112, s54
    v_xor_b32 v222, s53, v220
    v_and_b32 v222, 0x3ff, v222
    v_add_u32 v222, s54, v222
    s_lshl_b32 s53, s24, 4
    s_lshl_b32 s54, s24, 10
    s_add_u32 s54, s54, 16384
    s_cmp_ge_u32 s24, 16
    s_cselect_b32 s54, 90112, s54
    v_xor_b32 v223, s53, v220
    v_and_b32 v223, 0x3ff, v223
    v_add_u32 v223, s54, v223
    s_and_b32 s77, s3, 1
    v_lshlrev_b32 v224, 4, v1
    s_mul_i32 s53, s3, 6144
    s_add_u32 s53, s53, 65536
    v_add_u32 v225, s53, v224
    s_mul_i32 s53, s77, 3072
    s_add_u32 s53, s53, 65536
    v_add_u32 v226, s53, v224
    s_lshl_b32 s53, s77, 6
    s_add_u32 s53, s53, 152576
    v_lshlrev_b32 v227, 2, v3
    v_add_u32 v227, s53, v227
    v_lshlrev_b32 v228, 4, v2
    v_add_u32 v228, s53, v228
    s_cmp_eq_u32 s77, 0
    s_cselect_b32 s53, s12, s14
    v_lshl_add_u32 v229, v2, 2, 0
    v_cmp_gt_u32 vcc, s53, v229
    s_nop 1
    v_cndmask_b32 v232, v24, v32, vcc
    v_lshl_add_u32 v229, v2, 2, 1
    v_cmp_gt_u32 vcc, s53, v229
    s_nop 1
    v_cndmask_b32 v233, v25, v32, vcc
    v_lshl_add_u32 v229, v2, 2, 2
    v_cmp_gt_u32 vcc, s53, v229
    s_nop 1
    v_cndmask_b32 v234, v26, v32, vcc
    v_lshl_add_u32 v229, v2, 2, 3
    v_cmp_gt_u32 vcc, s53, v229
    s_nop 1
    v_cndmask_b32 v235, v27, v32, vcc
    v_subrev_u32 v229, 7, v3
    v_cmp_gt_u32 s[98:99], 8, v229
    v_lshlrev_b32 v229, 4, v229
    v_and_b32 v230, 1, v2
    v_lshl_add_u32 v229, v230, 10, v229
    v_lshrrev_b32 v230, 1, v2
    v_lshl_add_u32 v229, v230, 8, v229
    s_lshr_b32 s55, s5, 1
    s_lshl_b32 s55, s55, 11
    s_and_b32 s53, s5, 1
    s_lshl_b32 s53, s53, 9
    s_add_u32 s55, s55, s53
    s_lshl_b32 s53, s77, 7
    s_add_u32 s55, s55, s53
    s_add_u32 s55, s55, 81920
    s_lshl_b32 s53, s25, 2
    s_add_u32 s53, s53, 152576
    s_cmp_ge_u32 s25, 16
    s_cselect_b32 s53, 154112, s53
    v_mov_b32 v236, s53
    s_lshl_b32 s53, s24, 2
    s_add_u32 s53, s53, 152640
    s_cmp_ge_u32 s24, 16
    s_cselect_b32 s53, 154112, s53
    v_mov_b32 v237, s53
    v_mov_b32 v238, 152604
    v_mov_b32 v189, 153088
    s_waitcnt vmcnt(0)
    v_cmp_ne_u32 vcc, s90, v204
    v_cmp_ne_u32 s[96:97], s90, v205
    s_nop 0
    s_or_b64 vcc, vcc, s[96:97]
    s_cmp_eq_u64 vcc, 0
    s_nop 0
    s_cbranch_scc1 Lq_35
    s_mov_b32 s95, 0x200000
Lp_36:
    buffer_load_dword v204, v201, s[44:47], s20 offen sc1
    buffer_load_dword v205, v202, s[44:47], s21 offen sc1
    s_waitcnt vmcnt(0)
    v_cmp_ne_u32 vcc, s90, v204
    v_cmp_ne_u32 s[96:97], s90, v205
    s_nop 0
    s_or_b64 vcc, vcc, s[96:97]
    s_cmp_eq_u64 vcc, 0
    s_nop 0
    s_cbranch_scc1 Ld_37
    s_sleep 1
    s_sub_u32 s95, s95, 1
    s_cmp_lg_u32 s95, 0
    s_cbranch_scc1 Lp_36
    s_branch L_abort
Ld_37:
Lq_35:
    s_mov_b32 s52, 266240
    buffer_load_dword v204, v206, s[44:47], s52 offen sc1
    s_sub_u32 s74, s3, 1
    s_add_u32 s53, s74, 0
    v_readlane_b32 s52, v212, s53
    s_and_b32 s54, s53, 15
    s_lshl_b32 s54, s54, 4
    v_xor_b32 v210, s54, v209
    s_lshl_b32 m0, s53, 10
    s_cmp_eq_u32 s52, -1
    s_cselect_b64 exec, 0, -1
    buffer_load_dwordx4 v210, s[44:47], s52 offen sc1 lds
    s_mov_b64 exec, -1
    s_add_u32 s53, s74, 3
    v_readlane_b32 s52, v212, s53
    s_and_b32 s54, s53, 15
    s_lshl_b32 s54, s54, 4
    v_xor_b32 v210, s54, v209
    s_lshl_b32 m0, s53, 10
    s_cmp_eq_u32 s52, -1
    s_cselect_b64 exec, 0, -1
    buffer_load_dwordx4 v210, s[44:47], s52 offen sc1 lds
    s_mov_b64 exec, -1
    s_add_u32 s53, s74, 6
    v_readlane_b32 s52, v212, s53
    s_and_b32 s54, s53, 15
    s_lshl_b32 s54, s54, 4
    v_xor_b32 v210, s54, v209
    s_lshl_b32 m0, s53, 10
    s_cmp_eq_u32 s52, -1
    s_cselect_b64 exec, 0, -1
    buffer_load_dwordx4 v210, s[44:47], s52 offen sc1 lds
    s_mov_b64 exec, -1
    s_add_u32 s53, s74, 9
    v_readlane_b32 s52, v212, s53
    s_and_b32 s54, s53, 15
    s_lshl_b32 s54, s54, 4
    v_xor_b32 v210, s54, v209
    s_lshl_b32 m0, s53, 10
    s_cmp_eq_u32 s52, -1
    s_cselect_b64 exec, 0, -1
    buffer_load_dwordx4 v210, s[44:47], s52 offen sc1 lds
    s_mov_b64 exec, -1
    s_add_u32 s53, s74, 12
    v_readlane_b32 s52, v212, s53
    s_and_b32 s54, s53, 15
    s_lshl_b32 s54, s54, 4
    v_xor_b32 v210, s54, v209
    s_lshl_b32 m0, s53, 10
    s_cmp_eq_u32 s52, -1
    s_cselect_b64 exec, 0, -1
    buffer_load_dwordx4 v210, s[44:47], s52 offen sc1 lds
    s_mov_b64 exec, -1
    s_add_u32 s53, s74, 15
    v_readlane_b32 s52, v212, s53
    s_and_b32 s54, s53, 15
    s_lshl_b32 s54, s54, 4
    v_xor_b32 v210, s54, v209
    s_lshl_b32 m0, s53, 10
    s_cmp_eq_u32 s52, -1
    s_cselect_b64 exec, 0, -1
    buffer_load_dwordx4 v210, s[44:47], s52 offen sc1 lds
    s_mov_b64 exec, -1
    s_add_u32 s53, s74, 18
    v_readlane_b32 s52, v212, s53
    s_and_b32 s54, s53, 15
    s_lshl_b32 s54, s54, 4
    v_xor_b32 v210, s54, v209
    s_lshl_b32 m0, s53, 10
    s_cmp_eq_u32 s52, -1
    s_cselect_b64 exec, 0, -1
    buffer_load_dwordx4 v210, s[44:47], s52 offen sc1 lds
    s_mov_b64 exec, -1
    s_add_u32 s53, s74, 21
    v_readlane_b32 s52, v212, s53
    s_and_b32 s54, s53, 15
    s_lshl_b32 s54, s54, 4
    v_xor_b32 v210, s54, v209
    s_lshl_b32 m0, s53, 10
    s_cmp_eq_u32 s52, -1
    s_cselect_b64 exec, 0, -1
    buffer_load_dwordx4 v210, s[44:47], s52 offen sc1 lds
    s_mov_b64 exec, -1
    s_add_u32 s53, s74, 24
    v_readlane_b32 s52, v212, s53
    s_and_b32 s54, s53, 15
    s_lshl_b32 s54, s54, 4
    v_xor_b32 v210, s54, v209
    s_lshl_b32 m0, s53, 10
    s_cmp_eq_u32 s52, -1
    s_cselect_b64 exec, 0, -1
    buffer_load_dwordx4 v210, s[44:47], s52 offen sc1 lds
    s_mov_b64 exec, -1
    s_add_u32 s53, s74, 27
    v_readlane_b32 s52, v212, s53
    s_and_b32 s54, s53, 15
    s_lshl_b32 s54, s54, 4
    v_xor_b32 v210, s54, v209
    s_lshl_b32 m0, s53, 10
    s_cmp_eq_u32 s52, -1
    s_cselect_b64 exec, 0, -1
    buffer_load_dwordx4 v210, s[44:47], s52 offen sc1 lds
    s_mov_b64 exec, -1
    s_add_u32 s53, s74, 30
    s_min_u32 s53, s53, 31
    v_readlane_b32 s52, v212, s53
    s_and_b32 s54, s53, 15
    s_lshl_b32 s54, s54, 4
    v_xor_b32 v210, s54, v209
    s_lshl_b32 m0, s53, 10
    s_cmp_eq_u32 s52, -1
    s_cselect_b64 exec, 0, -1
    buffer_load_dwordx4 v210, s[44:47], s52 offen sc1 lds
    s_mov_b64 exec, -1
    s_waitcnt vmcnt(11)
    ds_write_b32 v208, v204
    s_branch L_Fj
L_Fred:
    v_lshlrev_b32 v220, 2, v0
    v_xor_b32 v221, 112, v220
    s_lshl_b32 s53, s25, 4
    s_lshl_b32 s54, s25, 10
    s_add_u32 s54, s54, 0
    s_cmp_ge_u32 s25, 16
    s_cselect_b32 s54, 90112, s54
    v_xor_b32 v222, s53, v220
    v_and_b32 v222, 0x3ff, v222
    v_add_u32 v222, s54, v222
    s_lshl_b32 s53, s24, 4
    s_lshl_b32 s54, s24, 10
    s_add_u32 s54, s54, 16384
    s_cmp_ge_u32 s24, 16
    s_cselect_b32 s54, 90112, s54
    v_xor_b32 v223, s53, v220
    v_and_b32 v223, 0x3ff, v223
    v_add_u32 v223, s54, v223
    s_and_b32 s77, s3, 1
    v_lshlrev_b32 v224, 4, v1
    s_mul_i32 s53, s3, 6144
    s_add_u32 s53, s53, 65536
    v_add_u32 v225, s53, v224
    s_mul_i32 s53, s77, 3072
    s_add_u32 s53, s53, 65536
    v_add_u32 v226, s53, v224
    s_lshl_b32 s53, s77, 6
    s_add_u32 s53, s53, 152576
    v_lshlrev_b32 v227, 2, v3
    v_add_u32 v227, s53, v227
    v_lshlrev_b32 v228, 4, v2
    v_add_u32 v228, s53, v228
    s_cmp_eq_u32 s77, 0
    s_cselect_b32 s53, s12, s14
    v_lshl_add_u32 v229, v2, 2, 0
    v_cmp_gt_u32 vcc, s53, v229
    s_nop 1
    v_cndmask_b32 v232, v24, v32, vcc
    v_lshl_add_u32 v229, v2, 2, 1
    v_cmp_gt_u32 vcc, s53, v229
    s_nop 1
    v_cndmask_b32 v233, v25, v32, vcc
    v_lshl_add_u32 v229, v2, 2, 2
    v_cmp_gt_u32 vcc, s53, v229
    s_nop 1
    v_cndmask_b32 v234, v26, v32, vcc
    v_lshl_add_u32 v229, v2, 2, 3
    v_cmp_gt_u32 vcc, s53, v229
    s_nop 1
    v_cndmask_b32 v235, v27, v32, vcc
    v_subrev_u32 v229, 7, v3
    v_cmp_gt_u32 s[98:99], 8, v229
    v_lshlrev_b32 v229, 4, v229
    v_and_b32 v230, 1, v2
    v_lshl_add_u32 v229, v230, 10, v229
    v_lshrrev_b32 v230, 1, v2
    v_lshl_add_u32 v229, v230, 8, v229
    s_lshr_b32 s55, s5, 1
    s_lshl_b32 s55, s55, 11
    s_and_b32 s53, s5, 1
    s_lshl_b32 s53, s53, 9
    s_add_u32 s55, s55, s53
    s_lshl_b32 s53, s77, 7
    s_add_u32 s55, s55, s53
    s_add_u32 s55, s55, 81920
    s_lshl_b32 s53, s25, 2
    s_add_u32 s53, s53, 152576
    s_cmp_ge_u32 s25, 16
    s_cselect_b32 s53, 154112, s53
    v_mov_b32 v236, s53
    s_lshl_b32 s53, s24, 2
    s_add_u32 s53, s53, 152640
    s_cmp_ge_u32 s24, 16
    s_cselect_b32 s53, 154112, s53
    v_mov_b32 v237, s53
    v_mov_b32 v238, 152604
    v_mov_b32 v189, 153088
L_Fj:
    v_lshlrev_b32 v160, 3, v0
    s_mov_b32 s52, 8192
    s_lshl_b32 s53, s3, 4
    s_add_u32 s53, s53, 153088
    v_mov_b32 v188, s53
    v_lshlrev_b32 v180, 16, v64
    v_lshlrev_b32 v182, 16, v65
    v_and_b32 v181, 0xffff0000, v64
    v_and_b32 v183, 0xffff0000, v65
    v_subrev_f32 v168, s82, v180
    v_subrev_f32 v170, s84, v182
    v_subrev_f32 v169, s82, v181
    v_subrev_f32 v171, s84, v183
    v_fma_f32 v180, v168, s83, v180
    v_fma_f32 v182, v170, s85, v182
    v_fma_f32 v181, v169, s83, v181
    v_fma_f32 v183, v171, s85, v183
    s_mov_b32 s95, 0x200000
Lp_38:
    buffer_load_dwordx2 v[164:165], v160, s[44:47], s52 offen sc1
    buffer_load_dwordx2 v[166:167], v160, s[44:47], s52 offen offset:2048 sc1
    s_waitcnt vmcnt(0)
    v_cmp_ne_u32 vcc, s90, v165
    v_cmp_ne_u32 s[96:97], s90, v167
    s_nop 0
    s_or_b64 vcc, vcc, s[96:97]
    s_cmp_eq_u64 vcc, 0
    s_nop 0
    s_cbranch_scc1 Ld_39
    s_sub_u32 s95, s95, 1
    s_cmp_lg_u32 s95, 0
    s_cbranch_scc1 Lp_38
    s_branch L_abort
Ld_39:
    v_and_b32 v165, 0xffff0000, v164
    v_and_b32 v167, 0xffff0000, v166
    v_lshlrev_b32 v164, 16, v164
    v_lshlrev_b32 v166, 16, v166
    v_pk_add_f32 v[180:181], v[180:181], v[164:165]
    v_pk_add_f32 v[182:183], v[182:183], v[166:167]
    v_cvt_pk_bf16_f32 v64, v180, v181
    v_cvt_pk_bf16_f32 v65, v182, v183
    v_add_f32 v172, v180, v181
    v_add_f32 v174, v182, v183
    v_mul_f32 v173, v180, v180
    v_mul_f32 v175, v182, v182
    v_fma_f32 v173, v181, v181, v173
    v_fma_f32 v175, v183, v183, v175
    ds_write_b32 v221, v64 offset:7168
    ds_write_b32 v221, v65 offset:23552
    ds_write_b32 v222, v65
    ds_write_b32 v223, v64
    v_add_f32_dpp v172, v172, v172 quad_perm:[1,0,3,2] row_mask:0xf bank_mask:0xf
    v_add_f32_dpp v173, v173, v173 quad_perm:[1,0,3,2] row_mask:0xf bank_mask:0xf
    v_add_f32_dpp v174, v174, v174 quad_perm:[1,0,3,2] row_mask:0xf bank_mask:0xf
    v_add_f32_dpp v175, v175, v175 quad_perm:[1,0,3,2] row_mask:0xf bank_mask:0xf
    v_add_f32_dpp v172, v172, v172 quad_perm:[2,3,0,1] row_mask:0xf bank_mask:0xf
    v_add_f32_dpp v173, v173, v173 quad_perm:[2,3,0,1] row_mask:0xf bank_mask:0xf
    v_add_f32_dpp v174, v174, v174 quad_perm:[2,3,0,1] row_mask:0xf bank_mask:0xf
    v_add_f32_dpp v175, v175, v175 quad_perm:[2,3,0,1] row_mask:0xf bank_mask:0xf
    v_add_f32_dpp v172, v172, v172 row_half_mirror row_mask:0xf bank_mask:0xf
    v_add_f32_dpp v173, v173, v173 row_half_mirror row_mask:0xf bank_mask:0xf
    v_add_f32_dpp v174, v174, v174 row_half_mirror row_mask:0xf bank_mask:0xf
    v_add_f32_dpp v175, v175, v175 row_half_mirror row_mask:0xf bank_mask:0xf
    v_add_f32_dpp v172, v172, v172 row_mirror row_mask:0xf bank_mask:0xf
    v_add_f32_dpp v173, v173, v173 row_mirror row_mask:0xf bank_mask:0xf
    v_add_f32_dpp v174, v174, v174 row_mirror row_mask:0xf bank_mask:0xf
    v_add_f32_dpp v175, v175, v175 row_mirror row_mask:0xf bank_mask:0xf
    v_add_f32_dpp v172, v172, v172 row_bcast:15 row_mask:0xa bank_mask:0xf
    v_add_f32_dpp v173, v173, v173 row_bcast:15 row_mask:0xa bank_mask:0xf
    v_add_f32_dpp v174, v174, v174 row_bcast:15 row_mask:0xa bank_mask:0xf
    v_add_f32_dpp v175, v175, v175 row_bcast:15 row_mask:0xa bank_mask:0xf
    v_add_f32_dpp v172, v172, v172 row_bcast:31 row_mask:0xc bank_mask:0xf
    v_add_f32_dpp v173, v173, v173 row_bcast:31 row_mask:0xc bank_mask:0xf
    v_add_f32_dpp v174, v174, v174 row_bcast:31 row_mask:0xc bank_mask:0xf
    v_add_f32_dpp v175, v175, v175 row_bcast:31 row_mask:0xc bank_mask:0xf
    s_mov_b32 exec_lo, 0
    s_mov_b32 exec_hi, 0x80000000
    ds_write_b128 v188, v[172:175]
    s_mov_b64 exec, -1
    s_waitcnt lgkmcnt(0)
    s_barrier
    ds_read_b128 v[96:99], v66 offset:0
    ds_read_b128 v[100:103], v67 offset:0
    ds_read_b128 v[104:107], v68 offset:0
    ds_read_b128 v[108:111], v69 offset:0
    ds_read_b128 v[192:195], v189 offset:0
    ds_read_b128 v[196:199], v189 offset:16
    ds_read_b128 v[200:203], v189 offset:32
    ds_read_b128 v[204:207], v189 offset:48
    ds_read_b128 v[112:115], v66 offset:16384
    ds_read_b128 v[116:119], v67 offset:16384
    ds_read_b128 v[120:123], v68 offset:16384
    ds_read_b128 v[124:127], v69 offset:16384
    s_waitcnt lgkmcnt(11)
    v_mfma_f32_16x16x32_bf16 v[128:131], a[192:195], v[96:99], 0
    s_waitcnt lgkmcnt(6)
    v_add_f32 v192, v192, v196
    v_add_f32 v193, v193, v197
    v_mfma_f32_16x16x32_bf16 v[132:135], a[196:199], v[96:99], 0
    v_add_f32 v194, v194, v198
    v_add_f32 v195, v195, v199
    v_mfma_f32_16x16x32_bf16 v[136:139], v[96:99], a[200:203], 0
    s_waitcnt lgkmcnt(4)
    v_add_f32 v200, v200, v204
    v_add_f32 v201, v201, v205
    v_mfma_f32_16x16x32_bf16 v[128:131], a[204:207], v[100:103], v[128:131]
    v_add_f32 v202, v202, v206
    v_add_f32 v203, v203, v207
    v_mfma_f32_16x16x32_bf16 v[132:135], a[208:211], v[100:103], v[132:135]
    v_add_f32 v192, v192, v200
    v_add_f32 v193, v193, v201
    v_mfma_f32_16x16x32_bf16 v[136:139], v[100:103], a[212:215], v[136:139]
    v_add_f32 v194, v194, v202
    v_add_f32 v195, v195, v203
    v_mfma_f32_16x16x32_bf16 v[128:131], a[216:219], v[104:107], v[128:131]
    v_mul_f32 v196, 0x3b000000, v192
    v_mul_f32 v202, 0x3b000000, v194
    v_mfma_f32_16x16x32_bf16 v[132:135], a[220:223], v[104:107], v[132:135]
    v_mul_f32 v197, 0x3b000000, v193
    v_mul_f32 v203, 0x3b000000, v195
    v_mfma_f32_16x16x32_bf16 v[136:139], v[104:107], a[224:227], v[136:139]
    v_fma_f32 v197, -v196, v196, v197
    v_fma_f32 v203, -v202, v202, v203
    v_mfma_f32_16x16x32_bf16 v[128:131], a[228:231], v[108:111], v[128:131]
    v_max_f32 v197, 0, v197
    v_max_f32 v203, 0, v203
    v_mfma_f32_16x16x32_bf16 v[132:135], a[232:235], v[108:111], v[132:135]
    v_cvt_pk_bf16_f32 v198, v197, v197
    v_cvt_pk_bf16_f32 v204, v203, v203
    v_mfma_f32_16x16x32_bf16 v[136:139], v[108:111], a[236:239], v[136:139]
    v_lshlrev_b32 v198, 16, v198
    v_lshlrev_b32 v204, 16, v204
    s_waitcnt lgkmcnt(0)
    v_mfma_f32_16x16x32_bf16 v[140:143], a[192:195], v[112:115], 0
    v_add_f32 v198, 0x3727c5ac, v198
    v_add_f32 v204, 0x3727c5ac, v204
    v_mfma_f32_16x16x32_bf16 v[144:147], a[196:199], v[112:115], 0
    v_cvt_pk_bf16_f32 v198, v198, v198
    v_cvt_pk_bf16_f32 v204, v204, v204
    v_mfma_f32_16x16x32_bf16 v[148:151], v[112:115], a[200:203], 0
    v_lshlrev_b32 v198, 16, v198
    v_lshlrev_b32 v204, 16, v204
    v_mfma_f32_16x16x32_bf16 v[140:143], a[204:207], v[116:119], v[140:143]
    v_sqrt_f32 v198, v198
    v_mfma_f32_16x16x32_bf16 v[144:147], a[208:211], v[116:119], v[144:147]
    v_sqrt_f32 v204, v204
    v_mfma_f32_16x16x32_bf16 v[148:151], v[116:119], a[212:215], v[148:151]
    v_cvt_pk_bf16_f32 v199, v196, v196
    v_cvt_pk_bf16_f32 v205, v202, v202
    v_mfma_f32_16x16x32_bf16 v[140:143], a[216:219], v[120:123], v[140:143]
    v_cvt_pk_bf16_f32 v198, v198, v198
    v_cvt_pk_bf16_f32 v204, v204, v204
    v_mfma_f32_16x16x32_bf16 v[144:147], a[220:223], v[120:123], v[144:147]
    v_lshlrev_b32 v198, 16, v198
    v_lshlrev_b32 v204, 16, v204
    v_mfma_f32_16x16x32_bf16 v[148:151], v[120:123], a[224:227], v[148:151]
    v_rcp_f32 v198, v198
    v_mfma_f32_16x16x32_bf16 v[140:143], a[228:231], v[124:127], v[140:143]
    v_rcp_f32 v204, v204
    v_mfma_f32_16x16x32_bf16 v[144:147], a[232:235], v[124:127], v[144:147]
    v_lshlrev_b32 v199, 16, v199
    v_lshlrev_b32 v205, 16, v205
    v_mfma_f32_16x16x32_bf16 v[148:151], v[124:127], a[236:239], v[148:151]
    v_sub_f32 v199, 0, v199
    v_sub_f32 v205, 0, v205
    v_mov_b32 v200, 1.0
    v_mov_b32 v206, 1.0
    v_mov_b32 v201, 0
    v_mov_b32 v207, 0
    ds_write2_b32 v238, v198, v199 offset0:0 offset1:32
    ds_write2_b32 v238, v200, v201 offset0:64 offset1:96
    ds_write2_b32 v238, v204, v205 offset0:16 offset1:48
    ds_write2_b32 v238, v206, v207 offset0:80 offset1:112
    ds_write2_b32 v236, v204, v205 offset0:0 offset1:32
    ds_write2_b32 v236, v206, v207 offset0:64 offset1:96
    ds_write2_b32 v237, v198, v199 offset0:0 offset1:32
    ds_write2_b32 v237, v200, v201 offset0:64 offset1:96
    ds_write_b128 v225, v[128:131] offset:0
    ds_write_b128 v225, v[132:135] offset:1024
    ds_write_b128 v225, v[136:139] offset:2048
    ds_write_b128 v225, v[140:143] offset:3072
    ds_write_b128 v225, v[144:147] offset:4096
    ds_write_b128 v225, v[148:151] offset:5120
    s_waitcnt lgkmcnt(0)
    s_barrier
    s_cmp_ge_u32 s3, 2
    s_cbranch_scc1 L_Fa
    ds_read_b128 v[96:99], v226 offset:0
    ds_read_b128 v[100:103], v226 offset:1024
    ds_read_b128 v[104:107], v226 offset:2048
    ds_read_b128 v[108:111], v226 offset:6144
    ds_read_b128 v[112:115], v226 offset:7168
    ds_read_b128 v[116:119], v226 offset:8192
    ds_read_b128 v[120:123], v226 offset:12288
    ds_read_b128 v[124:127], v226 offset:13312
    ds_read_b128 v[128:131], v226 offset:14336
    ds_read_b128 v[132:135], v226 offset:18432
    ds_read_b128 v[136:139], v226 offset:19456
    ds_read_b128 v[140:143], v226 offset:20480
    ds_read2_b32 v[164:165], v227 offset0:0 offset1:32
    ds_read_b128 v[168:171], v228
    ds_read_b128 v[176:179], v228 offset:128
    s_waitcnt lgkmcnt(11)
    v_pk_add_f32 v[96:97], v[96:97], v[108:109]
    s_waitcnt lgkmcnt(5)
    v_pk_add_f32 v[120:121], v[120:121], v[132:133]
    v_pk_add_f32 v[98:99], v[98:99], v[110:111]
    v_pk_add_f32 v[122:123], v[122:123], v[134:135]
    v_pk_add_f32 v[100:101], v[100:101], v[112:113]
    s_waitcnt lgkmcnt(4)
    v_pk_add_f32 v[124:125], v[124:125], v[136:137]
    v_pk_add_f32 v[102:103], v[102:103], v[114:115]
    v_pk_add_f32 v[126:127], v[126:127], v[138:139]
    v_pk_add_f32 v[104:105], v[104:105], v[116:117]
    s_waitcnt lgkmcnt(3)
    v_pk_add_f32 v[128:129], v[128:129], v[140:141]
    v_pk_add_f32 v[106:107], v[106:107], v[118:119]
    v_pk_add_f32 v[130:131], v[130:131], v[142:143]
    v_pk_add_f32 v[96:97], v[96:97], v[120:121]
    v_pk_add_f32 v[98:99], v[98:99], v[122:123]
    v_pk_add_f32 v[100:101], v[100:101], v[124:125]
    v_pk_add_f32 v[102:103], v[102:103], v[126:127]
    v_pk_add_f32 v[104:105], v[104:105], v[128:129]
    v_pk_add_f32 v[106:107], v[106:107], v[130:131]
    s_waitcnt lgkmcnt(2)
    v_pk_fma_f32 v[96:97], v[36:37], v[164:165], v[96:97] op_sel:[0,1,0] op_sel_hi:[1,1,1]
    v_pk_fma_f32 v[98:99], v[38:39], v[164:165], v[98:99] op_sel:[0,1,0] op_sel_hi:[1,1,1]
    v_pk_fma_f32 v[100:101], v[40:41], v[164:165], v[100:101] op_sel:[0,1,0] op_sel_hi:[1,1,1]
    v_pk_fma_f32 v[102:103], v[42:43], v[164:165], v[102:103] op_sel:[0,1,0] op_sel_hi:[1,1,1]
    s_waitcnt lgkmcnt(0)
    v_pk_fma_f32 v[104:105], v[176:177], v[44:45], v[104:105] op_sel_hi:[1,0,1]
    v_pk_fma_f32 v[106:107], v[178:179], v[44:45], v[106:107] op_sel_hi:[1,0,1]
    v_pk_mul_f32 v[100:101], v[100:101], v[164:165] op_sel_hi:[1,0]
    v_pk_mul_f32 v[102:103], v[102:103], v[164:165] op_sel_hi:[1,0]
    v_pk_mul_f32 v[104:105], v[104:105], v[168:169]
    v_pk_mul_f32 v[106:107], v[106:107], v[170:171]
    v_cvt_pk_bf16_f32 v108, v96, v97
    v_cvt_pk_bf16_f32 v109, v98, v99
    v_cvt_pk_bf16_f32 v110, v100, v101
    v_cvt_pk_bf16_f32 v111, v102, v103
    v_cvt_pk_bf16_f32 v112, v104, v105
    v_cvt_pk_bf16_f32 v113, v106, v107
    v_mul_f32 v164, s79, v164
    v_mfma_f32_16x16x16_bf16 v[96:99], v[110:111], v[108:109], v[232:235]
    s_nop 7
    v_max3_f32 v166, v96, v97, v98
    v_max_f32 v166, v166, v99
    v_mov_b32 v167, v166
    s_nop 1
    v_permlane16_swap_b32 v166, v167
    v_max_f32 v166, v166, v167
    v_mov_b32 v167, v166
    s_nop 1
    v_permlane32_swap_b32 v166, v167
    v_max_f32 v166, v166, v167
    v_mul_f32 v165, v166, v164
    v_fma_f32 v96, v96, v164, -v165
    v_fma_f32 v97, v97, v164, -v165
    v_fma_f32 v98, v98, v164, -v165
    v_fma_f32 v99, v99, v164, -v165
    v_exp_f32 v96, v96
    v_exp_f32 v97, v97
    v_exp_f32 v98, v98
    v_exp_f32 v99, v99
    v_cvt_pk_bf16_f32 v96, v96, v97
    v_cvt_pk_bf16_f32 v97, v98, v99
    s_nop 1
    v_mfma_f32_16x16x16_bf16 v[100:103], v[20:21], v[96:97], 0
    v_mfma_f32_16x16x16_bf16 v[104:107], v[112:113], v[96:97], 0
    s_nop 6
    v_rcp_f32 v100, v100
    s_nop 0
    v_mul_f32 v104, v104, v100
    v_mul_f32 v105, v105, v100
    v_mul_f32 v106, v106, v100
    v_mul_f32 v107, v107, v100
    v_cvt_pk_bf16_f32 v96, v104, v105
    v_mov_b32 v97, s90
    v_cvt_pk_bf16_f32 v98, v106, v107
    v_mov_b32 v99, s90
    s_mov_b64 exec, s[98:99]
    s_cmp_eq_u32 s91, 1
    s_cbranch_scc0 Ls_40
    buffer_store_dwordx4 v[96:99], v229, s[44:47], s55 offen
    s_nop 0
    s_branch Le_41
Ls_40:
    buffer_store_dwordx4 v[96:99], v229, s[44:47], s55 offen sc1
Le_41:
    s_mov_b64 exec, -1
L_Fa:
    v_and_b32 v166, 7, v3
    v_add_u32 v166, 7, v166
    v_lshrrev_b32 v167, 3, v3
    s_lshl_b32 s52, s5, 1
    v_lshrrev_b32 v168, 1, v2
    v_add_u32 v168, s52, v168
    v_xor_b32 v168, v168, v166
    v_lshlrev_b32 v168, 4, v168
    v_lshl_add_u32 v168, v166, 10, v168
    v_lshl_add_u32 v168, v167, 14, v168
    v_and_b32 v169, 1, v2
    v_lshl_add_u32 v168, v169, 3, v168
    v_lshl_add_u32 v169, v167, 4, v166
    v_lshlrev_b32 v169, 2, v169
    v_add_u32 v169, 152832, v169
    ds_read_b64 v[170:171], v168 offset:0
    ds_read2_b32 v[172:173], v169 offset0:0 offset1:32
    v_cmp_eq_u32 vcc, 0, v167
    v_mov_b32 v174, s9
    v_mov_b32 v175, s8
    v_cndmask_b32 v174, v174, v175, vcc
    v_lshl_add_u32 v77, v166, 1, v174
    v_subrev_u32 v77, 14, v77
    v_lshlrev_b32 v161, 4, v1
    v_add_u32 v161, 65536, v161
    s_lshl_b32 s52, s3, 10
    v_add_u32 v162, s52, v161
    s_waitcnt lgkmcnt(1)
    v_lshlrev_b32 v70, 16, v170
    v_and_b32 v71, 0xffff0000, v170
    v_lshlrev_b32 v72, 16, v171
    v_and_b32 v73, 0xffff0000, v171
    s_waitcnt lgkmcnt(0)
    v_pk_fma_f32 v[70:71], v[70:71], v[172:173], v[172:173] op_sel:[0,0,1] op_sel_hi:[1,0,1]
    v_pk_fma_f32 v[72:73], v[72:73], v[172:173], v[172:173] op_sel:[0,0,1] op_sel_hi:[1,0,1]
    v_lshlrev_b32 v176, 4, v1
    s_lshl_b32 s52, s3, 13
    s_add_u32 s52, s52, 81920
    s_add_u32 s53, s52, 4096
    s_mov_b32 s95, 0x200000
Lp_42:
    buffer_load_dwordx4 v[120:123], v176, s[44:47], s52 offen offset:0 sc1
    buffer_load_dwordx4 v[124:127], v176, s[44:47], s52 offen offset:1024 sc1
    buffer_load_dwordx4 v[128:131], v176, s[44:47], s52 offen offset:2048 sc1
    buffer_load_dwordx4 v[132:135], v176, s[44:47], s52 offen offset:3072 sc1
    buffer_load_dwordx4 v[136:139], v176, s[44:47], s53 offen offset:0 sc1
    buffer_load_dwordx4 v[140:143], v176, s[44:47], s53 offen offset:1024 sc1
    buffer_load_dwordx4 v[144:147], v176, s[44:47], s53 offen offset:2048 sc1
    buffer_load_dwordx4 v[148:151], v176, s[44:47], s53 offen offset:3072 sc1
    s_waitcnt vmcnt(0)
    v_cmp_ne_u32 vcc, s90, v121
    v_cmp_ne_u32 s[96:97], s90, v123
    s_nop 0
    s_or_b64 vcc, vcc, s[96:97]
    v_cmp_ne_u32 s[96:97], s90, v125
    s_nop 0
    s_or_b64 vcc, vcc, s[96:97]
    v_cmp_ne_u32 s[96:97], s90, v127
    s_nop 0
    s_or_b64 vcc, vcc, s[96:97]
    v_cmp_ne_u32 s[96:97], s90, v129
    s_nop 0
    s_or_b64 vcc, vcc, s[96:97]
    v_cmp_ne_u32 s[96:97], s90, v131
    s_nop 0
    s_or_b64 vcc, vcc, s[96:97]
    v_cmp_ne_u32 s[96:97], s90, v133
    s_nop 0
    s_or_b64 vcc, vcc, s[96:97]
    v_cmp_ne_u32 s[96:97], s90, v135
    s_nop 0
    s_or_b64 vcc, vcc, s[96:97]
    v_cmp_ne_u32 s[96:97], s90, v137
    s_nop 0
    s_or_b64 vcc, vcc, s[96:97]
    v_cmp_ne_u32 s[96:97], s90, v139
    s_nop 0
    s_or_b64 vcc, vcc, s[96:97]
    v_cmp_ne_u32 s[96:97], s90, v141
    s_nop 0
    s_or_b64 vcc, vcc, s[96:97]
    v_cmp_ne_u32 s[96:97], s90, v143
    s_nop 0
    s_or_b64 vcc, vcc, s[96:97]
    v_cmp_ne_u32 s[96:97], s90, v145
    s_nop 0
    s_or_b64 vcc, vcc, s[96:97]
    v_cmp_ne_u32 s[96:97], s90, v147
    s_nop 0
    s_or_b64 vcc, vcc, s[96:97]
    v_cmp_ne_u32 s[96:97], s90, v149
    s_nop 0
    s_or_b64 vcc, vcc, s[96:97]
    v_cmp_ne_u32 s[96:97], s90, v151
    s_nop 0
    s_or_b64 vcc, vcc, s[96:97]
    s_cmp_eq_u64 vcc, 0
    s_nop 0
    s_cbranch_scc1 Ld_43
    s_sub_u32 s95, s95, 1
    s_cmp_lg_u32 s95, 0
    s_cbranch_scc1 Lp_42
    s_branch L_abort
Ld_43:
    v_mov_b32 v121, v122
    v_mov_b32 v122, v124
    v_mov_b32 v123, v126
    v_mov_b32 v129, v130
    v_mov_b32 v130, v132
    v_mov_b32 v131, v134
    v_mov_b32 v137, v138
    v_mov_b32 v138, v140
    v_mov_b32 v139, v142
    v_mov_b32 v145, v146
    v_mov_b32 v146, v148
    v_mov_b32 v147, v150
    v_mfma_f32_16x16x32_bf16 v[112:115], a[240:243], v[120:123], 0
    v_mfma_f32_16x16x32_bf16 v[112:115], a[244:247], v[128:131], v[112:115]
    v_mfma_f32_16x16x32_bf16 v[112:115], a[248:251], v[136:139], v[112:115]
    v_mfma_f32_16x16x32_bf16 v[112:115], a[252:255], v[144:147], v[112:115]
    s_nop 7
    ds_write_b128 v162, v[112:115]
    v_lshlrev_b32 v165, 11, v3
    v_lshl_add_u32 v165, v2, 4, v165
    s_lshl_b32 s52, s5, 6
    s_add_u32 s52, s52, 114688
    s_waitcnt lgkmcnt(0)
    s_barrier
    s_cmp_lg_u32 s3, 0
    s_cbranch_scc1 L_Fb
    ds_read_b128 v[96:99], v161 offset:0
    ds_read_b128 v[100:103], v161 offset:1024
    ds_read_b128 v[104:107], v161 offset:2048
    ds_read_b128 v[108:111], v161 offset:3072
    s_waitcnt lgkmcnt(3)
    v_pk_add_f32 v[70:71], v[70:71], v[96:97]
    v_pk_add_f32 v[72:73], v[72:73], v[98:99]
    s_waitcnt lgkmcnt(2)
    v_pk_add_f32 v[70:71], v[70:71], v[100:101]
    v_pk_add_f32 v[72:73], v[72:73], v[102:103]
    s_waitcnt lgkmcnt(1)
    v_pk_add_f32 v[70:71], v[70:71], v[104:105]
    v_pk_add_f32 v[72:73], v[72:73], v[106:107]
    s_waitcnt lgkmcnt(0)
    v_pk_add_f32 v[70:71], v[70:71], v[108:109]
    v_pk_add_f32 v[72:73], v[72:73], v[110:111]
    v_cvt_pk_bf16_f32 v112, v70, v71
    v_cvt_pk_bf16_f32 v113, v72, v73
    v_pk_mul_f32 v[100:101], v[70:71], v[70:71]
    v_pk_mul_f32 v[102:103], v[72:73], v[72:73]
    v_cvt_pk_bf16_f32 v100, v100, v101
    v_cvt_pk_bf16_f32 v101, v102, v103
    v_mfma_f32_16x16x16_bf16 v[104:107], v[48:49], v[112:113], 0
    s_nop 0
    v_mfma_f32_16x16x16_bf16 v[104:107], v[50:51], v[100:101], v[104:107]
    v_mov_b32 v116, v112
    v_mov_b32 v117, s90
    v_mov_b32 v118, v113
    v_mov_b32 v119, s90
    v_lshlrev_b32 v166, 4, v1
    s_lshl_b32 s53, s5, 8
    s_add_u32 s53, s53, 147456
    s_nop 0
    v_mov_b32 v107, s90
    s_cmp_eq_u32 s91, 1
    s_cbranch_scc0 Ls_44
    s_mov_b64 exec, 0xffff
    buffer_store_dwordx4 v[104:107], v166, s[44:47], s53 offen
    s_mov_b64 exec, -1
    buffer_store_dwordx4 v[116:119], v165, s[44:47], s52 offen
    s_nop 0
    s_branch Le_45
Ls_44:
    s_mov_b64 exec, 0xffff
    buffer_store_dwordx4 v[104:107], v166, s[44:47], s53 offen sc1
    s_mov_b64 exec, -1
    buffer_store_dwordx4 v[116:119], v165, s[44:47], s52 offen sc1
Le_45:
    s_mov_b32 s95, 0x200000
Lp_46:
    s_mov_b32 s52, 147456
    buffer_load_dwordx4 v[120:123], v166, s[44:47], s52 offen offset:0 sc1
    s_mov_b32 s52, 147456
    buffer_load_dwordx4 v[124:127], v166, s[44:47], s52 offen offset:1024 sc1
    s_mov_b32 s52, 147456
    buffer_load_dwordx4 v[128:131], v166, s[44:47], s52 offen offset:2048 sc1
    s_mov_b32 s52, 147456
    buffer_load_dwordx4 v[132:135], v166, s[44:47], s52 offen offset:3072 sc1
    s_mov_b32 s52, 151552
    buffer_load_dwordx4 v[136:139], v166, s[44:47], s52 offen offset:0 sc1
    s_mov_b32 s52, 151552
    buffer_load_dwordx4 v[140:143], v166, s[44:47], s52 offen offset:1024 sc1
    s_mov_b32 s52, 151552
    buffer_load_dwordx4 v[144:147], v166, s[44:47], s52 offen offset:2048 sc1
    s_mov_b32 s52, 151552
    buffer_load_dwordx4 v[148:151], v166, s[44:47], s52 offen offset:3072 sc1
    s_waitcnt vmcnt(0)
    v_cmp_ne_u32 vcc, s90, v123
    v_cmp_ne_u32 s[96:97], s90, v127
    s_nop 0
    s_or_b64 vcc, vcc, s[96:97]
    v_cmp_ne_u32 s[96:97], s90, v131
    s_nop 0
    s_or_b64 vcc, vcc, s[96:97]
    v_cmp_ne_u32 s[96:97], s90, v135
    s_nop 0
    s_or_b64 vcc, vcc, s[96:97]
    v_cmp_ne_u32 s[96:97], s90, v139
    s_nop 0
    s_or_b64 vcc, vcc, s[96:97]
    v_cmp_ne_u32 s[96:97], s90, v143
    s_nop 0
    s_or_b64 vcc, vcc, s[96:97]
    v_cmp_ne_u32 s[96:97], s90, v147
    s_nop 0
    s_or_b64 vcc, vcc, s[96:97]
    v_cmp_ne_u32 s[96:97], s90, v151
    s_nop 0
    s_or_b64 vcc, vcc, s[96:97]
    s_cmp_eq_u64 vcc, 0
    s_nop 0
    s_cbranch_scc1 Ld_47
    s_sub_u32 s95, s95, 1
    s_cmp_lg_u32 s95, 0
    s_cbranch_scc1 Lp_46
    s_branch L_abort
Ld_47:
    v_pk_add_f32 v[120:121], v[120:121], v[136:137]
    v_add_f32 v122, v122, v138
    v_pk_add_f32 v[124:125], v[124:125], v[140:141]
    v_add_f32 v126, v126, v142
    v_pk_add_f32 v[128:129], v[128:129], v[144:145]
    v_add_f32 v130, v130, v146
    v_pk_add_f32 v[132:133], v[132:133], v[148:149]
    v_add_f32 v134, v134, v150
    v_pk_add_f32 v[120:121], v[120:121], v[128:129]
    v_add_f32 v122, v122, v130
    v_pk_add_f32 v[124:125], v[124:125], v[132:133]
    v_add_f32 v126, v126, v134
    v_pk_add_f32 v[120:121], v[120:121], v[124:125]
    v_add_f32 v122, v122, v126
    v_mov_b32 v124, v120
    v_mov_b32 v125, v121
    v_mov_b32 v126, v122
    v_permlane16_swap_b32 v120, v124
    v_permlane16_swap_b32 v121, v125
    v_permlane16_swap_b32 v122, v126
    v_add_f32 v120, v120, v124
    v_add_f32 v121, v121, v125
    v_add_f32 v122, v122, v126
    v_mov_b32 v124, v120
    v_mov_b32 v125, v121
    v_mov_b32 v126, v122
    v_permlane32_swap_b32 v120, v124
    v_permlane32_swap_b32 v121, v125
    v_permlane32_swap_b32 v122, v126
    v_add_f32 v120, v120, v124
    v_add_f32 v121, v121, v125
    v_add_f32 v122, v122, v126
    v_mul_f32 v100, 0x3b000000, v120
    v_mul_f32 v101, 0x3b000000, v122
    v_fma_f32 v101, -v100, v100, v101
    v_max_f32 v101, 0, v101
    v_cvt_pk_bf16_f32 v76, v101, v101
    v_lshlrev_b32 v76, 16, v76
    v_add_f32 v76, 0x3727c5ac, v76
    v_cvt_pk_bf16_f32 v76, v76, v76
    v_lshlrev_b32 v76, 16, v76
    v_sqrt_f32 v76, v76
    v_cvt_pk_bf16_f32 v75, v100, v100
    v_cvt_pk_bf16_f32 v76, v76, v76
    v_lshlrev_b32 v76, 16, v76
    v_rcp_f32 v76, v76
    v_lshlrev_b32 v75, 16, v75
    v_fma_f32 v121, -v75, s93, v121
    v_mul_f32 v121, v121, v76
    v_ashrrev_i32 v96, 31, v121
    v_or_b32 v96, 0x80000000, v96
    v_xor_b32 v96, v96, v121
    s_mov_b32 s52, 0xfffff800
    v_and_or_b32 v96, v96, s52, v77
    s_movk_i32 s52, 2048
    v_cmp_gt_u32 vcc, s52, v77
    s_nop 1
    v_cndmask_b32 v74, 0, v96, vcc
    v_mov_b32 v96, v74
    s_nop 1
    v_max_u32_dpp v96, v96, v96 quad_perm:[1,0,3,2] row_mask:0xf bank_mask:0xf
    s_nop 1
    v_max_u32_dpp v96, v96, v96 quad_perm:[2,3,0,1] row_mask:0xf bank_mask:0xf
    s_nop 1
    v_max_u32_dpp v96, v96, v96 row_half_mirror row_mask:0xf bank_mask:0xf
    s_nop 1
    v_max_u32_dpp v96, v96, v96 row_mirror row_mask:0xf bank_mask:0xf
    s_nop 1
    v_max_u32_dpp v96, v96, v96 row_bcast:15 row_mask:0xa bank_mask:0xf
    s_nop 1
    v_max_u32_dpp v96, v96, v96 row_bcast:31 row_mask:0xc bank_mask:0xf
    s_nop 0
    v_readlane_b32 s70, v96, 63
    s_nop 1
    v_cmp_ne_u32 vcc, s70, v74
    s_nop 1
    v_cndmask_b32 v96, 0, v74, vcc
    s_nop 1
    v_max_u32_dpp v96, v96, v96 quad_perm:[1,0,3,2] row_mask:0xf bank_mask:0xf
    s_nop 1
    v_max_u32_dpp v96, v96, v96 quad_perm:[2,3,0,1] row_mask:0xf bank_mask:0xf
    s_nop 1
    v_max_u32_dpp v96, v96, v96 row_half_mirror row_mask:0xf bank_mask:0xf
    s_nop 1
    v_max_u32_dpp v96, v96, v96 row_mirror row_mask:0xf bank_mask:0xf
    s_nop 1
    v_max_u32_dpp v96, v96, v96 row_bcast:15 row_mask:0xa bank_mask:0xf
    s_nop 1
    v_max_u32_dpp v96, v96, v96 row_bcast:31 row_mask:0xc bank_mask:0xf
    s_nop 0
    v_readlane_b32 s71, v96, 63
    v_mov_b32 v100, v74
    v_mov_b32 v101, v75
    v_mov_b32 v102, v76
    v_lshlrev_b32 v103, 11, v3
    v_add_u32 v103, 114688, v103
    v_mov_b32 v104, 152512
    v_mov_b32 v105, 152528
    v_cmp_eq_u32 vcc, s71, v100
    s_nop 1
    v_cndmask_b32 v104, v104, v105, vcc
    v_cmp_eq_u32 s[96:97], s70, v100
    s_nop 0
    s_or_b64 exec, vcc, s[96:97]
    ds_write_b128 v104, v[100:103]
    s_mov_b64 exec, -1
L_Fb:
    v_and_b32 v96, 1, v1
    v_lshlrev_b32 v96, 4, v96
    v_add_u32 v96, 152512, v96
    v_add_u32 v8, 4096, v8
    v_mov_b32 v4, 0
    v_mov_b32 v7, s90
    s_waitcnt lgkmcnt(0)
    s_barrier
    ds_read_b128 v[100:103], v96
    s_mov_b32 exec_lo, 0
    s_mov_b32 exec_hi, 0x3000000
    s_waitcnt lgkmcnt(0)
    v_mov_b32 v4, v100
    v_mov_b32 v5, v101
    v_mov_b32 v6, v102
    v_mov_b32 v8, v103
    s_mov_b64 exec, -1
    s_mov_b32 s92, 1
    s_branch L_Floop
L_Fout:
    s_mov_b64 exec, 0xffff
    v_add_f32 v180, v180, v164
    v_add_f32 v181, v181, v165
    v_cvt_pk_bf16_f32 v180, v180, v180
    v_cvt_pk_bf16_f32 v181, v181, v181
    v_lshlrev_b32 v180, 16, v180
    v_lshlrev_b32 v181, 16, v181
    v_add_f32 v180, v180, v178
    v_add_f32 v181, v181, v179
    v_cvt_pk_bf16_f32 v180, v180, v180
    v_cvt_pk_bf16_f32 v181, v181, v181
    buffer_store_short v180, v182, s[48:51], s74 offen
    buffer_store_short v181, v182, s[48:51], s75 offen
    s_mov_b64 exec, -1
    s_cmp_lg_u32 s5, 0
    s_cbranch_scc1 L_fin
    s_add_u32 s52, s94, 1
    v_mov_b32 v160, s52
    v_mov_b32 v161, 0
    buffer_store_dword v160, v161, s[44:47], 0 offen
L_abort:
L_fin:
L_end:
    s_endpgm
L_code_end:
.section .rodata,"a"
.p2align 6
.amdhsa_kernel interleave_layers__sliding_local_dilated__moe_arch_mod__prompt_kernel
  .amdhsa_next_free_vgpr 512
  .amdhsa_next_free_sgpr 102
  .amdhsa_accum_offset 256
  .amdhsa_group_segment_fixed_size 0
  .amdhsa_kernarg_size 88
  .amdhsa_user_sgpr_count 2
  .amdhsa_user_sgpr_kernarg_segment_ptr 1
  .amdhsa_system_sgpr_workgroup_id_x 1
.end_amdhsa_kernel
```
